```python
import torch

def _softmax(x, axis=-1):
    return torch.softmax(x, dim=axis)
def _gelu(x):
    return torch.nn.functional.gelu(x, approximate="tanh")
def _silu(x):
    return torch.nn.functional.silu(x)
def _sigmoid(x):
    return torch.sigmoid(x)
def _layernorm(x, axis=-1, eps=1e-5):
    m = x.mean(dim=axis, keepdim=True)
    v = x.var(dim=axis, keepdim=True, unbiased=False)
    return (x - m) / torch.sqrt(v + eps)
def _scatter_add(tgt, idx, src, axis=0):
    return tgt.clone().index_add_(axis, idx, src)
def _segment_sum(src, seg, n):
    out = torch.zeros((n,) + src.shape[1:], dtype=src.dtype)
    return out.index_add_(0, seg, src)
def _pad(x, pw):
    flat = tuple(v for pair in reversed(pw) for v in pair)
    return torch.nn.functional.pad(x, flat)

kernel_name = 'standalone__mha_softmax__near_ridge'

def setup_inputs():

    _w = (lambda a: (lambda t: t.to(torch.bfloat16) if t.is_floating_point() else t)(torch.as_tensor(a)))
    B, H, Sq, Sk, D = 32, 32, 384, 384, 192
    return {
        "q": _w((lambda *s: torch.randn(*s, dtype=torch.bfloat16) * 0.8)(B, H, Sq, D)),
        "k": _w((lambda *s: torch.randn(*s, dtype=torch.bfloat16) * 0.8)(B, H, Sk, D)),
        "v": _w((lambda *s: torch.randn(*s, dtype=torch.bfloat16) * 0.05)(B, H, Sk, D)),
    }

def reference(q, k, v):
    scale = q.shape[-1] ** -0.5
    scores = torch.einsum("bhqd,bhkd->bhqk", q, k) * scale
    p = _softmax(scores, axis=-1)
    return torch.einsum("bhqk,bhkd->bhqd", p, v)
```

```asm
; @launch grid=(256,1,1) block=(512,1,1) lds=163840
.amdgcn_target "amdgcn-amd-amdhsa--gfx950"
.text
.globl standalone__mha_softmax__near_ridge_kernel
.p2align 8
.type standalone__mha_softmax__near_ridge_kernel,@function
standalone__mha_softmax__near_ridge_kernel:
    s_cmp_ge_u32 s2, 256
    s_cbranch_scc1 L_end
    s_load_dwordx4 s[4:7], s[0:1], 0
    s_load_dwordx4 s[36:39], s[0:1], 16
    v_lshrrev_b32 v2, 6, v0
    v_and_b32 v1, 63, v0
    v_readfirstlane_b32 s40, v2
    v_and_b32 v3, 15, v1
    v_lshrrev_b32 v4, 4, v1
    v_mul_u32_u24 v5, 384, v3
    v_lshrrev_b32 v6, 1, v3
    v_xor_b32 v6, v6, v4
    v_lshl_add_u32 v250, v6, 4, v5
    v_xor_b32 v6, 4, v6
    v_lshl_add_u32 v251, v6, 4, v5
    v_mul_u32_u24 v5, 24, v2
    v_lshrrev_b32 v6, 3, v1
    v_add_u32 v5, v5, v6
    v_mul_u32_u24 v5, 384, v5
    v_lshlrev_b32 v6, 1, v4
    v_and_b32 v7, 7, v1
    v_xor_b32 v6, v6, v7
    v_lshl_add_u32 v252, v6, 4, v5
    s_mul_i32 s30, s40, 3072
    s_lshl_b32 s32, s40, 2
    s_lshl_b32 s43, s40, 11
    v_mbcnt_lo_u32_b32 v213, -1, 0
    v_mbcnt_hi_u32_b32 v213, -1, v213
    v_lshrrev_b32 v214, 2, v213
    v_bfe_u32 v215, v213, 3, 2
    v_lshlrev_b32 v215, 5, v215
    v_lshl_add_u32 v214, v214, 7, v215
    v_and_b32 v215, 3, v213
    v_lshl_add_u32 v204, v215, 3, v214
    v_xor_b32 v205, 32, v204
    v_xor_b32 v206, 64, v204
    v_xor_b32 v207, 96, v204
    v_add_u32 v214, 0, v213
    v_mul_u32_u24 v214, 2731, v214
    v_lshrrev_b32 v214, 17, v214
    v_add_u32 v214, s32, v214
    v_and_b32 v214, 7, v214
    v_xor_b32 v214, v214, v213
    v_lshl_add_u32 v208, v214, 4, s30
    v_add_u32 v214, 64, v213
    v_mul_u32_u24 v214, 2731, v214
    v_lshrrev_b32 v214, 17, v214
    v_add_u32 v214, s32, v214
    v_and_b32 v214, 7, v214
    v_xor_b32 v214, v214, v213
    v_lshl_add_u32 v209, v214, 4, s30
    v_add_u32 v214, 128, v213
    v_mul_u32_u24 v214, 2731, v214
    v_lshrrev_b32 v214, 17, v214
    v_add_u32 v214, s32, v214
    v_and_b32 v214, 7, v214
    v_xor_b32 v214, v214, v213
    v_lshl_add_u32 v210, v214, 4, s30
    v_and_b32 v214, 15, v213
    v_mul_u32_u24 v214, 384, v214
    s_mul_i32 s34, s30, 6
    v_add_u32 v214, s34, v214
    v_bfe_u32 v215, v213, 3, 1
    v_mul_u32_u24 v215, 3008, v215
    v_sub_u32 v214, v214, v215
    v_lshrrev_b32 v215, 4, v213
    v_lshl_add_u32 v211, v215, 4, v214
    v_bfe_u32 v215, v213, 4, 1
    v_lshl_add_u32 v214, v215, 5, v214
    v_lshrrev_b32 v215, 5, v213
    v_lshl_add_u32 v212, v215, 4, v214
    s_waitcnt lgkmcnt(0)
    s_mov_b32 s8, s4
    s_and_b32 s9, s5, 0xffff
    s_mov_b32 s10, 150994944
    s_mov_b32 s11, 0x00020000
    s_mov_b32 s12, s6
    s_and_b32 s13, s7, 0xffff
    s_mov_b32 s14, 150994944
    s_mov_b32 s15, 0x00020000
    s_mov_b32 s16, s36
    s_and_b32 s17, s37, 0xffff
    s_mov_b32 s18, 150994944
    s_mov_b32 s19, 0x00020000
    s_mov_b32 s20, s38
    s_and_b32 s21, s39, 0xffff
    s_mov_b32 s22, 150994944
    s_mov_b32 s23, 0x00020000
    s_mov_b32 s29, 0x3dd53b95
    s_mov_b32 s48, 0x45000000
    s_mov_b32 s49, 0x3dd53b95
    s_mov_b32 s33, 0x41000000
    s_mov_b32 s35, s2
    s_mov_b32 s28, 0
    s_mov_b32 s26, 0x10000000
    s_mul_i32 s25, s35, 147456
    s_cmp_ge_u32 s35, 1024
    s_cselect_b32 s25, 0x10000000, s25
    s_add_u32 s35, s35, 256
    s_add_u32 m0, s30, 0
    s_add_u32 s31, s25, 0
    buffer_load_dwordx4 v208, s[12:15], s31 offen offset:0 nt lds
    buffer_load_dwordx4 v209, s[12:15], s31 offen offset:1024 nt lds
    buffer_load_dwordx4 v210, s[12:15], s31 offen offset:2048 nt lds
    s_add_u32 s42, s25, 0
    s_add_u32 m0, s30, 49152
    s_nop 0
    buffer_load_dwordx4 v211, s[8:11], s42 offen nt lds
    s_add_u32 s42, s25, 3072
    s_add_u32 m0, s30, 73728
    s_nop 0
    buffer_load_dwordx4 v211, s[8:11], s42 offen nt lds
    s_add_u32 s42, s25, 128
    s_add_u32 m0, s30, 50176
    s_nop 0
    buffer_load_dwordx4 v211, s[8:11], s42 offen nt lds
    s_add_u32 s42, s25, 3200
    s_add_u32 m0, s30, 74752
    s_nop 0
    buffer_load_dwordx4 v211, s[8:11], s42 offen nt lds
    s_add_u32 s42, s25, 256
    s_add_u32 m0, s30, 51200
    s_nop 0
    buffer_load_dwordx4 v211, s[8:11], s42 offen nt lds
    s_add_u32 s42, s25, 3328
    s_add_u32 m0, s30, 75776
    s_nop 0
    buffer_load_dwordx4 v211, s[8:11], s42 offen nt lds
    s_add_u32 s42, s25, 6144
    s_add_u32 m0, s30, 98304
    s_nop 0
    buffer_load_dwordx4 v211, s[8:11], s42 offen nt lds
    s_add_u32 s42, s25, 9216
    s_add_u32 m0, s30, 99328
    s_nop 0
    buffer_load_dwordx4 v211, s[8:11], s42 offen nt lds
    s_add_u32 s42, s25, 6272
    s_add_u32 m0, s43, 147456
    s_nop 0
    buffer_load_dwordx4 v211, s[8:11], s42 offen nt lds
    s_add_u32 s42, s25, 9344
    s_add_u32 m0, s43, 148480
    s_nop 0
    buffer_load_dwordx4 v211, s[8:11], s42 offen nt lds
    s_add_u32 s42, s25, 6400
    buffer_load_dwordx4 v[0:3], v211, s[8:11], s42 offen nt
    s_add_u32 s42, s25, 9472
    buffer_load_dwordx4 v[4:7], v211, s[8:11], s42 offen nt
    s_add_u32 s42, s25, 12288
    buffer_load_dwordx4 v[8:11], v211, s[8:11], s42 offen nt
    s_add_u32 s42, s25, 15360
    buffer_load_dwordx4 v[12:15], v211, s[8:11], s42 offen nt
    s_add_u32 s42, s25, 12416
    buffer_load_dwordx4 v[16:19], v211, s[8:11], s42 offen nt
    s_add_u32 s42, s25, 15488
    buffer_load_dwordx4 v[20:23], v211, s[8:11], s42 offen nt
    s_add_u32 s42, s25, 12544
    buffer_load_dwordx4 v[24:27], v211, s[8:11], s42 offen nt
    s_add_u32 s42, s25, 15616
    buffer_load_dwordx4 v[28:31], v211, s[8:11], s42 offen nt
    s_add_u32 m0, s30, 24576
    s_add_u32 s31, s25, 24576
    buffer_load_dwordx4 v208, s[12:15], s31 offen offset:0 nt lds
    buffer_load_dwordx4 v209, s[12:15], s31 offen offset:1024 nt lds
    buffer_load_dwordx4 v210, s[12:15], s31 offen offset:2048 nt lds
    s_waitcnt vmcnt(3)
    s_barrier
    s_branch L_entry
.p2align 6
L_head:
    s_mov_b64 s[44:45], 0
    v_mfma_f32_16x16x32_bf16 v[0:3], v[228:231], v[156:159], 0
    ds_read_b128 v[240:243], v251 offset:128
    v_mov_b32 v120, v144
    v_mov_b32 v121, v145
    v_mov_b32 v122, v146
    v_mfma_f32_16x16x32_bf16 v[4:7], v[228:231], v[180:183], 0
    v_mov_b32 v123, v147
    v_mov_b32 v124, v148
    v_mov_b32 v125, v149
    v_mov_b32 v126, v150
    v_mfma_f32_16x16x32_bf16 v[8:11], v[228:231], v[204:207], 0
    v_mov_b32 v127, v151
    v_mov_b32 v128, v152
    v_mov_b32 v129, v153
    s_add_u32 m0, s30, 49152
    s_add_u32 s31, s24, 49152
    buffer_load_dwordx4 v132, s[12:15], s31 offen offset:0 nt lds
    buffer_load_dwordx4 v133, s[12:15], s31 offen offset:1024 nt lds
    buffer_load_dwordx4 v134, s[12:15], s31 offen offset:2048 nt lds
    v_mfma_f32_16x16x32_bf16 v[0:3], v[232:235], v[160:163], v[0:3]
    ds_read_b128 v[228:231], v250 offset:256
    v_mov_b32 v130, v154
    v_mov_b32 v131, v155
    v_permlane16_swap_b32 v96, v98
    v_mfma_f32_16x16x32_bf16 v[4:7], v[232:235], v[184:187], v[4:7]
    v_permlane16_swap_b32 v97, v99
    v_permlane16_swap_b32 v100, v102
    v_permlane16_swap_b32 v101, v103
    v_mov_b32 v253, v96
    v_mfma_f32_16x16x32_bf16 v[8:11], v[232:235], v[208:211], v[8:11]
    v_mov_b32 v254, v97
    v_mov_b32_dpp v96, v100 row_ror:8 row_mask:0xf bank_mask:0xc
    v_mov_b32_dpp v97, v101 row_ror:8 row_mask:0xf bank_mask:0xc
    s_waitcnt lgkmcnt(1)
    v_mfma_f32_16x16x32_bf16 v[0:3], v[236:239], v[164:167], v[0:3]
    ds_read_b128 v[232:235], v251 offset:256
    v_mov_b32_dpp v100, v253 row_ror:8 row_mask:0xf bank_mask:0x3
    v_mov_b32_dpp v101, v254 row_ror:8 row_mask:0xf bank_mask:0x3
    v_mov_b32 v253, v98
    v_mfma_f32_16x16x32_bf16 v[4:7], v[236:239], v[188:191], v[4:7]
    v_mov_b32 v254, v99
    v_mov_b32_dpp v98, v102 row_ror:8 row_mask:0xf bank_mask:0xc
    v_mov_b32_dpp v99, v103 row_ror:8 row_mask:0xf bank_mask:0xc
    v_mov_b32_dpp v102, v253 row_ror:8 row_mask:0xf bank_mask:0x3
    v_mfma_f32_16x16x32_bf16 v[8:11], v[236:239], v[212:215], v[8:11]
    v_mov_b32_dpp v103, v254 row_ror:8 row_mask:0xf bank_mask:0x3
    v_permlane16_swap_b32 v104, v106
    v_permlane16_swap_b32 v105, v107
    v_mfma_f32_16x16x32_bf16 v[0:3], v[240:243], v[168:171], v[0:3]
    ds_read_b128 v[236:239], v250 offset:6144
    v_permlane16_swap_b32 v108, v110
    v_permlane16_swap_b32 v109, v111
    v_mov_b32 v253, v104
    v_mfma_f32_16x16x32_bf16 v[4:7], v[240:243], v[192:195], v[4:7]
    v_mov_b32 v254, v105
    v_mov_b32_dpp v104, v108 row_ror:8 row_mask:0xf bank_mask:0xc
    v_mov_b32_dpp v105, v109 row_ror:8 row_mask:0xf bank_mask:0xc
    v_mov_b32_dpp v108, v253 row_ror:8 row_mask:0xf bank_mask:0x3
    v_mfma_f32_16x16x32_bf16 v[8:11], v[240:243], v[216:219], v[8:11]
    v_mov_b32_dpp v109, v254 row_ror:8 row_mask:0xf bank_mask:0x3
    v_mov_b32 v253, v106
    v_mov_b32 v254, v107
    s_waitcnt lgkmcnt(1)
    v_mfma_f32_16x16x32_bf16 v[0:3], v[228:231], v[172:175], v[0:3]
    ds_read_b128 v[240:243], v251 offset:6144
    v_mov_b32_dpp v106, v110 row_ror:8 row_mask:0xf bank_mask:0xc
    v_mov_b32_dpp v107, v111 row_ror:8 row_mask:0xf bank_mask:0xc
    v_mov_b32_dpp v110, v253 row_ror:8 row_mask:0xf bank_mask:0x3
    v_mfma_f32_16x16x32_bf16 v[4:7], v[228:231], v[196:199], v[4:7]
    v_mov_b32_dpp v111, v254 row_ror:8 row_mask:0xf bank_mask:0x3
    v_permlane16_swap_b32 v112, v114
    v_permlane16_swap_b32 v113, v115
    v_permlane16_swap_b32 v116, v118
    v_mfma_f32_16x16x32_bf16 v[8:11], v[228:231], v[220:223], v[8:11]
    v_permlane16_swap_b32 v117, v119
    v_mov_b32 v253, v112
    v_mov_b32 v254, v113
    v_mfma_f32_16x16x32_bf16 v[0:3], v[232:235], v[176:179], v[0:3]
    ds_read_b128 v[228:231], v250 offset:6272
    v_mov_b32_dpp v112, v116 row_ror:8 row_mask:0xf bank_mask:0xc
    v_mov_b32_dpp v113, v117 row_ror:8 row_mask:0xf bank_mask:0xc
    v_mov_b32_dpp v116, v253 row_ror:8 row_mask:0xf bank_mask:0x3
    v_mfma_f32_16x16x32_bf16 v[4:7], v[232:235], v[200:203], v[4:7]
    v_mov_b32_dpp v117, v254 row_ror:8 row_mask:0xf bank_mask:0x3
    v_mov_b32 v253, v114
    v_mov_b32 v254, v115
    v_mov_b32_dpp v114, v118 row_ror:8 row_mask:0xf bank_mask:0xc
    v_mfma_f32_16x16x32_bf16 v[8:11], v[232:235], v[224:227], v[8:11]
    v_mov_b32_dpp v115, v119 row_ror:8 row_mask:0xf bank_mask:0xc
    v_mov_b32_dpp v118, v253 row_ror:8 row_mask:0xf bank_mask:0x3
    v_mov_b32_dpp v119, v254 row_ror:8 row_mask:0xf bank_mask:0x3
    s_waitcnt lgkmcnt(1)
    v_mfma_f32_16x16x32_bf16 v[144:147], v[236:239], v[156:159], 0
    ds_read_b128 v[232:235], v251 offset:6272
    v_mfma_f32_16x16x32_bf16 v[148:151], v[236:239], v[180:183], 0
    v_mfma_f32_16x16x32_bf16 v[152:155], v[236:239], v[204:207], 0
    v_mfma_f32_16x16x32_bf16 v[144:147], v[240:243], v[160:163], v[144:147]
    ds_read_b128 v[236:239], v250 offset:6400
    v_mfma_f32_16x16x32_bf16 v[148:151], v[240:243], v[184:187], v[148:151]
    v_mfma_f32_16x16x32_bf16 v[152:155], v[240:243], v[208:211], v[152:155]
    s_waitcnt lgkmcnt(1)
    v_mfma_f32_16x16x32_bf16 v[144:147], v[228:231], v[164:167], v[144:147]
    ds_read_b128 v[240:243], v251 offset:6400
    v_max3_f32 v253, v0, v1, v2
    v_max_f32 v253, v253, v3
    v_mov_b32 v254, v253
    s_nop 1
    v_permlane16_swap_b32 v253, v254
    s_nop 1
    v_max_f32 v253, v253, v254
    v_mfma_f32_16x16x32_bf16 v[148:151], v[228:231], v[188:191], v[148:151]
    v_mov_b32 v254, v253
    s_nop 1
    v_permlane32_swap_b32 v253, v254
    s_nop 1
    v_max_f32 v253, v253, v254
    v_mul_f32 v245, s29, v253
    v_add_f32 v245, s33, v245
    v_mfma_f32_16x16x32_bf16 v[152:155], v[228:231], v[212:215], v[152:155]
    v_max3_f32 v253, v4, v5, v6
    v_max_f32 v253, v253, v7
    v_mov_b32 v254, v253
    s_nop 1
    v_permlane16_swap_b32 v253, v254
    s_nop 1
    v_max_f32 v253, v253, v254
    v_mfma_f32_16x16x32_bf16 v[144:147], v[232:235], v[168:171], v[144:147]
    ds_read_b128 v[228:231], v250 offset:12288
    v_mov_b32 v254, v253
    s_nop 1
    v_permlane32_swap_b32 v253, v254
    s_nop 1
    v_max_f32 v253, v253, v254
    v_mul_f32 v247, s29, v253
    v_add_f32 v247, s33, v247
    v_mfma_f32_16x16x32_bf16 v[148:151], v[232:235], v[192:195], v[148:151]
    v_max3_f32 v253, v8, v9, v10
    v_max_f32 v253, v253, v11
    v_mov_b32 v254, v253
    s_nop 1
    v_permlane16_swap_b32 v253, v254
    s_nop 1
    v_max_f32 v253, v253, v254
    v_mfma_f32_16x16x32_bf16 v[152:155], v[232:235], v[216:219], v[152:155]
    v_mov_b32 v254, v253
    s_nop 1
    v_permlane32_swap_b32 v253, v254
    s_nop 1
    v_max_f32 v253, v253, v254
    v_mul_f32 v249, s29, v253
    v_add_f32 v249, s33, v249
    s_waitcnt lgkmcnt(1)
    v_mfma_f32_16x16x32_bf16 v[144:147], v[236:239], v[172:175], v[144:147]
    ds_read_b128 v[232:235], v251 offset:12288
    v_fma_f32 v0, v0, s29, -v245
    v_fma_f32 v1, v1, s29, -v245
    v_fma_f32 v2, v2, s29, -v245
    v_fma_f32 v3, v3, s29, -v245
    v_fma_f32 v4, v4, s29, -v247
    v_fma_f32 v5, v5, s29, -v247
    v_fma_f32 v6, v6, s29, -v247
    v_mfma_f32_16x16x32_bf16 v[148:151], v[236:239], v[196:199], v[148:151]
    v_fma_f32 v7, v7, s29, -v247
    v_fma_f32 v8, v8, s29, -v249
    v_fma_f32 v9, v9, s29, -v249
    v_fma_f32 v10, v10, s29, -v249
    v_fma_f32 v11, v11, s29, -v249
    v_exp_f32 v0, v0
    v_mfma_f32_16x16x32_bf16 v[152:155], v[236:239], v[220:223], v[152:155]
    v_exp_f32 v1, v1
    v_exp_f32 v2, v2
    v_exp_f32 v3, v3
    v_cvt_pk_bf16_f32 v0, v0, v1
    v_mfma_f32_16x16x32_bf16 v[144:147], v[240:243], v[176:179], v[144:147]
    ds_read_b128 v[236:239], v250 offset:12416
    v_exp_f32 v4, v4
    v_exp_f32 v5, v5
    v_cvt_pk_bf16_f32 v1, v2, v3
    v_exp_f32 v6, v6
    v_mfma_f32_16x16x32_bf16 v[148:151], v[240:243], v[200:203], v[148:151]
    v_exp_f32 v7, v7
    v_cvt_pk_bf16_f32 v4, v4, v5
    v_exp_f32 v8, v8
    v_exp_f32 v9, v9
    v_mfma_f32_16x16x32_bf16 v[152:155], v[240:243], v[224:227], v[152:155]
    v_cvt_pk_bf16_f32 v5, v6, v7
    v_exp_f32 v10, v10
    v_exp_f32 v11, v11
    v_cvt_pk_bf16_f32 v8, v8, v9
    v_cvt_pk_bf16_f32 v9, v10, v11
    s_waitcnt lgkmcnt(1)
    v_mfma_f32_16x16x32_bf16 v[12:15], v[228:231], v[156:159], 0
    ds_read_b128 v[240:243], v251 offset:12416
    v_mfma_f32_16x16x32_bf16 v[16:19], v[228:231], v[180:183], 0
    v_mfma_f32_16x16x32_bf16 v[20:23], v[228:231], v[204:207], 0
    s_add_u32 m0, s30, 73728
    s_add_u32 s31, s24, 73728
    buffer_load_dwordx4 v132, s[12:15], s31 offen offset:0 nt lds
    buffer_load_dwordx4 v133, s[12:15], s31 offen offset:1024 nt lds
    buffer_load_dwordx4 v134, s[12:15], s31 offen offset:2048 nt lds
    v_mfma_f32_16x16x32_bf16 v[12:15], v[232:235], v[160:163], v[12:15]
    ds_read_b128 v[228:231], v250 offset:12544
    v_mfma_f32_16x16x32_bf16 v[16:19], v[232:235], v[184:187], v[16:19]
    v_mfma_f32_16x16x32_bf16 v[20:23], v[232:235], v[208:211], v[20:23]
    s_waitcnt lgkmcnt(1)
    v_mfma_f32_16x16x32_bf16 v[12:15], v[236:239], v[164:167], v[12:15]
    ds_read_b128 v[232:235], v251 offset:12544
    v_fma_f32 v144, v144, s29, -v245
    v_fma_f32 v145, v145, s29, -v245
    v_fma_f32 v146, v146, s29, -v245
    v_fma_f32 v147, v147, s29, -v245
    v_mfma_f32_16x16x32_bf16 v[16:19], v[236:239], v[188:191], v[16:19]
    v_fma_f32 v148, v148, s29, -v247
    v_fma_f32 v149, v149, s29, -v247
    v_fma_f32 v150, v150, s29, -v247
    v_mfma_f32_16x16x32_bf16 v[20:23], v[236:239], v[212:215], v[20:23]
    v_fma_f32 v151, v151, s29, -v247
    v_fma_f32 v152, v152, s29, -v249
    v_fma_f32 v153, v153, s29, -v249
    v_fma_f32 v154, v154, s29, -v249
    v_mfma_f32_16x16x32_bf16 v[12:15], v[240:243], v[168:171], v[12:15]
    ds_read_b128 v[236:239], v250 offset:18432
    v_fma_f32 v155, v155, s29, -v249
    v_exp_f32 v144, v144
    v_mfma_f32_16x16x32_bf16 v[16:19], v[240:243], v[192:195], v[16:19]
    v_exp_f32 v145, v145
    v_exp_f32 v146, v146
    v_mfma_f32_16x16x32_bf16 v[20:23], v[240:243], v[216:219], v[20:23]
    v_exp_f32 v147, v147
    v_cvt_pk_bf16_f32 v2, v144, v145
    s_waitcnt lgkmcnt(1)
    v_mfma_f32_16x16x32_bf16 v[12:15], v[228:231], v[172:175], v[12:15]
    ds_read_b128 v[240:243], v251 offset:18432
    v_exp_f32 v148, v148
    v_exp_f32 v149, v149
    v_mfma_f32_16x16x32_bf16 v[16:19], v[228:231], v[196:199], v[16:19]
    v_cvt_pk_bf16_f32 v3, v146, v147
    v_exp_f32 v150, v150
    v_mfma_f32_16x16x32_bf16 v[20:23], v[228:231], v[220:223], v[20:23]
    v_exp_f32 v151, v151
    v_cvt_pk_bf16_f32 v6, v148, v149
    v_mfma_f32_16x16x32_bf16 v[12:15], v[232:235], v[176:179], v[12:15]
    ds_read_b128 v[228:231], v250 offset:18560
    v_exp_f32 v152, v152
    v_exp_f32 v153, v153
    v_mfma_f32_16x16x32_bf16 v[16:19], v[232:235], v[200:203], v[16:19]
    v_cvt_pk_bf16_f32 v7, v150, v151
    v_exp_f32 v154, v154
    v_mfma_f32_16x16x32_bf16 v[20:23], v[232:235], v[224:227], v[20:23]
    v_exp_f32 v155, v155
    v_cvt_pk_bf16_f32 v10, v152, v153
    v_cvt_pk_bf16_f32 v11, v154, v155
    s_waitcnt lgkmcnt(1)
    v_mfma_f32_16x16x32_bf16 v[144:147], v[236:239], v[156:159], 0
    ds_read_b128 v[232:235], v251 offset:18560
    v_mfma_f32_16x16x32_bf16 v[148:151], v[236:239], v[180:183], 0
    v_mfma_f32_16x16x32_bf16 v[152:155], v[236:239], v[204:207], 0
    v_mfma_f32_16x16x32_bf16 v[144:147], v[240:243], v[160:163], v[144:147]
    ds_read_b128 v[236:239], v250 offset:18688
    v_mfma_f32_16x16x32_bf16 v[148:151], v[240:243], v[184:187], v[148:151]
    v_mfma_f32_16x16x32_bf16 v[152:155], v[240:243], v[208:211], v[152:155]
    s_waitcnt lgkmcnt(1)
    v_mfma_f32_16x16x32_bf16 v[144:147], v[228:231], v[164:167], v[144:147]
    ds_read_b128 v[240:243], v251 offset:18688
    v_fma_f32 v12, v12, s29, -v245
    v_fma_f32 v13, v13, s29, -v245
    v_fma_f32 v14, v14, s29, -v245
    v_fma_f32 v15, v15, s29, -v245
    v_mfma_f32_16x16x32_bf16 v[148:151], v[228:231], v[188:191], v[148:151]
    v_fma_f32 v16, v16, s29, -v247
    v_fma_f32 v17, v17, s29, -v247
    v_fma_f32 v18, v18, s29, -v247
    v_mfma_f32_16x16x32_bf16 v[152:155], v[228:231], v[212:215], v[152:155]
    v_fma_f32 v19, v19, s29, -v247
    v_fma_f32 v20, v20, s29, -v249
    v_fma_f32 v21, v21, s29, -v249
    v_fma_f32 v22, v22, s29, -v249
    v_mfma_f32_16x16x32_bf16 v[144:147], v[232:235], v[168:171], v[144:147]
    v_fma_f32 v23, v23, s29, -v249
    v_exp_f32 v12, v12
    v_mfma_f32_16x16x32_bf16 v[148:151], v[232:235], v[192:195], v[148:151]
    v_exp_f32 v13, v13
    v_exp_f32 v14, v14
    v_mfma_f32_16x16x32_bf16 v[152:155], v[232:235], v[216:219], v[152:155]
    v_exp_f32 v15, v15
    v_cvt_pk_bf16_f32 v12, v12, v13
    s_waitcnt lgkmcnt(0)
    v_mfma_f32_16x16x32_bf16 v[144:147], v[236:239], v[172:175], v[144:147]
    v_exp_f32 v16, v16
    v_exp_f32 v17, v17
    v_mfma_f32_16x16x32_bf16 v[148:151], v[236:239], v[196:199], v[148:151]
    v_cvt_pk_bf16_f32 v13, v14, v15
    v_exp_f32 v18, v18
    v_mfma_f32_16x16x32_bf16 v[152:155], v[236:239], v[220:223], v[152:155]
    v_exp_f32 v19, v19
    v_cvt_pk_bf16_f32 v16, v16, v17
    v_mfma_f32_16x16x32_bf16 v[144:147], v[240:243], v[176:179], v[144:147]
    v_exp_f32 v20, v20
    v_exp_f32 v21, v21
    v_mfma_f32_16x16x32_bf16 v[148:151], v[240:243], v[200:203], v[148:151]
    v_cvt_pk_bf16_f32 v17, v18, v19
    v_exp_f32 v22, v22
    v_mfma_f32_16x16x32_bf16 v[152:155], v[240:243], v[224:227], v[152:155]
    v_exp_f32 v23, v23
    v_cvt_pk_bf16_f32 v20, v20, v21
    v_cvt_pk_bf16_f32 v21, v22, v23
    s_waitcnt vmcnt(6)
    s_barrier
    ds_read_b128 v[228:231], v250 offset:24576
    ds_read_b128 v[232:235], v251 offset:24576
    ds_read_b128 v[236:239], v250 offset:24704
    s_waitcnt lgkmcnt(1)
    v_mfma_f32_16x16x32_bf16 v[24:27], v[228:231], v[156:159], 0
    ds_read_b128 v[240:243], v251 offset:24704
    v_fma_f32 v144, v144, s29, -v245
    v_fma_f32 v145, v145, s29, -v245
    v_mfma_f32_16x16x32_bf16 v[28:31], v[228:231], v[180:183], 0
    v_fma_f32 v146, v146, s29, -v245
    v_fma_f32 v147, v147, s29, -v245
    v_fma_f32 v148, v148, s29, -v247
    v_mfma_f32_16x16x32_bf16 v[32:35], v[228:231], v[204:207], 0
    v_fma_f32 v149, v149, s29, -v247
    v_fma_f32 v150, v150, s29, -v247
    s_add_u32 m0, s30, 98304
    s_add_u32 s31, s24, 98304
    buffer_load_dwordx4 v132, s[12:15], s31 offen offset:0 nt lds
    buffer_load_dwordx4 v133, s[12:15], s31 offen offset:1024 nt lds
    buffer_load_dwordx4 v134, s[12:15], s31 offen offset:2048 nt lds
    v_mfma_f32_16x16x32_bf16 v[24:27], v[232:235], v[160:163], v[24:27]
    ds_read_b128 v[228:231], v250 offset:24832
    v_fma_f32 v151, v151, s29, -v247
    v_fma_f32 v152, v152, s29, -v249
    v_mfma_f32_16x16x32_bf16 v[28:31], v[232:235], v[184:187], v[28:31]
    v_fma_f32 v153, v153, s29, -v249
    v_fma_f32 v154, v154, s29, -v249
    v_fma_f32 v155, v155, s29, -v249
    v_mfma_f32_16x16x32_bf16 v[32:35], v[232:235], v[208:211], v[32:35]
    v_exp_f32 v144, v144
    s_waitcnt lgkmcnt(1)
    v_mfma_f32_16x16x32_bf16 v[24:27], v[236:239], v[164:167], v[24:27]
    ds_read_b128 v[232:235], v251 offset:24832
    v_exp_f32 v145, v145
    v_mfma_f32_16x16x32_bf16 v[28:31], v[236:239], v[188:191], v[28:31]
    v_exp_f32 v146, v146
    v_mfma_f32_16x16x32_bf16 v[32:35], v[236:239], v[212:215], v[32:35]
    v_exp_f32 v147, v147
    v_cvt_pk_bf16_f32 v14, v144, v145
    v_mfma_f32_16x16x32_bf16 v[24:27], v[240:243], v[168:171], v[24:27]
    ds_read_b128 v[236:239], v250 offset:30720
    v_exp_f32 v148, v148
    v_mfma_f32_16x16x32_bf16 v[28:31], v[240:243], v[192:195], v[28:31]
    v_exp_f32 v149, v149
    v_cvt_pk_bf16_f32 v15, v146, v147
    v_mfma_f32_16x16x32_bf16 v[32:35], v[240:243], v[216:219], v[32:35]
    v_exp_f32 v150, v150
    s_waitcnt lgkmcnt(1)
    v_mfma_f32_16x16x32_bf16 v[24:27], v[228:231], v[172:175], v[24:27]
    ds_read_b128 v[240:243], v251 offset:30720
    v_exp_f32 v151, v151
    v_mfma_f32_16x16x32_bf16 v[28:31], v[228:231], v[196:199], v[28:31]
    v_cvt_pk_bf16_f32 v18, v148, v149
    v_exp_f32 v152, v152
    v_mfma_f32_16x16x32_bf16 v[32:35], v[228:231], v[220:223], v[32:35]
    v_exp_f32 v153, v153
    v_mfma_f32_16x16x32_bf16 v[24:27], v[232:235], v[176:179], v[24:27]
    ds_read_b128 v[228:231], v250 offset:30848
    v_cvt_pk_bf16_f32 v19, v150, v151
    v_exp_f32 v154, v154
    v_mfma_f32_16x16x32_bf16 v[28:31], v[232:235], v[200:203], v[28:31]
    v_exp_f32 v155, v155
    v_mfma_f32_16x16x32_bf16 v[32:35], v[232:235], v[224:227], v[32:35]
    v_cvt_pk_bf16_f32 v22, v152, v153
    v_cvt_pk_bf16_f32 v23, v154, v155
    s_waitcnt lgkmcnt(1)
    v_mfma_f32_16x16x32_bf16 v[144:147], v[236:239], v[156:159], 0
    ds_read_b128 v[232:235], v251 offset:30848
    v_mfma_f32_16x16x32_bf16 v[148:151], v[236:239], v[180:183], 0
    v_mfma_f32_16x16x32_bf16 v[152:155], v[236:239], v[204:207], 0
    s_add_u32 s34, s27, 0
    buffer_store_dwordx4 v[96:99], v135, s[20:23], s34 offen offset:256
    v_mfma_f32_16x16x32_bf16 v[144:147], v[240:243], v[160:163], v[144:147]
    ds_read_b128 v[236:239], v250 offset:30976
    v_mfma_f32_16x16x32_bf16 v[148:151], v[240:243], v[184:187], v[148:151]
    v_mfma_f32_16x16x32_bf16 v[152:155], v[240:243], v[208:211], v[152:155]
    s_waitcnt lgkmcnt(1)
    v_mfma_f32_16x16x32_bf16 v[144:147], v[228:231], v[164:167], v[144:147]
    ds_read_b128 v[240:243], v251 offset:30976
    v_fma_f32 v24, v24, s29, -v245
    v_fma_f32 v25, v25, s29, -v245
    v_fma_f32 v26, v26, s29, -v245
    v_fma_f32 v27, v27, s29, -v245
    v_mfma_f32_16x16x32_bf16 v[148:151], v[228:231], v[188:191], v[148:151]
    v_fma_f32 v28, v28, s29, -v247
    v_fma_f32 v29, v29, s29, -v247
    v_fma_f32 v30, v30, s29, -v247
    v_mfma_f32_16x16x32_bf16 v[152:155], v[228:231], v[212:215], v[152:155]
    v_fma_f32 v31, v31, s29, -v247
    v_fma_f32 v32, v32, s29, -v249
    v_fma_f32 v33, v33, s29, -v249
    v_fma_f32 v34, v34, s29, -v249
    v_mfma_f32_16x16x32_bf16 v[144:147], v[232:235], v[168:171], v[144:147]
    ds_read_b128 v[228:231], v250 offset:36864
    v_fma_f32 v35, v35, s29, -v249
    v_exp_f32 v24, v24
    v_mfma_f32_16x16x32_bf16 v[148:151], v[232:235], v[192:195], v[148:151]
    v_exp_f32 v25, v25
    v_exp_f32 v26, v26
    v_mfma_f32_16x16x32_bf16 v[152:155], v[232:235], v[216:219], v[152:155]
    v_exp_f32 v27, v27
    v_cvt_pk_bf16_f32 v24, v24, v25
    s_waitcnt lgkmcnt(1)
    v_mfma_f32_16x16x32_bf16 v[144:147], v[236:239], v[172:175], v[144:147]
    ds_read_b128 v[232:235], v251 offset:36864
    v_exp_f32 v28, v28
    v_exp_f32 v29, v29
    v_mfma_f32_16x16x32_bf16 v[148:151], v[236:239], v[196:199], v[148:151]
    v_cvt_pk_bf16_f32 v25, v26, v27
    v_exp_f32 v30, v30
    v_mfma_f32_16x16x32_bf16 v[152:155], v[236:239], v[220:223], v[152:155]
    v_exp_f32 v31, v31
    v_cvt_pk_bf16_f32 v28, v28, v29
    v_mfma_f32_16x16x32_bf16 v[144:147], v[240:243], v[176:179], v[144:147]
    ds_read_b128 v[236:239], v250 offset:36992
    v_exp_f32 v32, v32
    v_exp_f32 v33, v33
    v_mfma_f32_16x16x32_bf16 v[148:151], v[240:243], v[200:203], v[148:151]
    v_cvt_pk_bf16_f32 v29, v30, v31
    v_exp_f32 v34, v34
    v_mfma_f32_16x16x32_bf16 v[152:155], v[240:243], v[224:227], v[152:155]
    v_exp_f32 v35, v35
    v_cvt_pk_bf16_f32 v32, v32, v33
    v_cvt_pk_bf16_f32 v33, v34, v35
    s_waitcnt lgkmcnt(1)
    v_mfma_f32_16x16x32_bf16 v[36:39], v[228:231], v[156:159], 0
    ds_read_b128 v[240:243], v251 offset:36992
    v_mfma_f32_16x16x32_bf16 v[40:43], v[228:231], v[180:183], 0
    v_mfma_f32_16x16x32_bf16 v[44:47], v[228:231], v[204:207], 0
    s_add_u32 s34, s27, 0
    buffer_store_dwordx4 v[100:103], v135, s[20:23], s34 offen offset:3328
    v_mfma_f32_16x16x32_bf16 v[36:39], v[232:235], v[160:163], v[36:39]
    ds_read_b128 v[228:231], v250 offset:37120
    v_mfma_f32_16x16x32_bf16 v[40:43], v[232:235], v[184:187], v[40:43]
    v_mfma_f32_16x16x32_bf16 v[44:47], v[232:235], v[208:211], v[44:47]
    s_waitcnt lgkmcnt(1)
    v_mfma_f32_16x16x32_bf16 v[36:39], v[236:239], v[164:167], v[36:39]
    ds_read_b128 v[232:235], v251 offset:37120
    v_fma_f32 v144, v144, s29, -v245
    v_fma_f32 v145, v145, s29, -v245
    v_fma_f32 v146, v146, s29, -v245
    v_fma_f32 v147, v147, s29, -v245
    v_mfma_f32_16x16x32_bf16 v[40:43], v[236:239], v[188:191], v[40:43]
    v_fma_f32 v148, v148, s29, -v247
    v_fma_f32 v149, v149, s29, -v247
    v_fma_f32 v150, v150, s29, -v247
    v_mfma_f32_16x16x32_bf16 v[44:47], v[236:239], v[212:215], v[44:47]
    v_fma_f32 v151, v151, s29, -v247
    v_fma_f32 v152, v152, s29, -v249
    v_fma_f32 v153, v153, s29, -v249
    v_fma_f32 v154, v154, s29, -v249
    v_mfma_f32_16x16x32_bf16 v[36:39], v[240:243], v[168:171], v[36:39]
    ds_read_b128 v[236:239], v250 offset:43008
    v_fma_f32 v155, v155, s29, -v249
    v_exp_f32 v144, v144
    v_mfma_f32_16x16x32_bf16 v[40:43], v[240:243], v[192:195], v[40:43]
    v_exp_f32 v145, v145
    v_exp_f32 v146, v146
    v_mfma_f32_16x16x32_bf16 v[44:47], v[240:243], v[216:219], v[44:47]
    v_exp_f32 v147, v147
    v_cvt_pk_bf16_f32 v26, v144, v145
    s_waitcnt lgkmcnt(1)
    v_mfma_f32_16x16x32_bf16 v[36:39], v[228:231], v[172:175], v[36:39]
    ds_read_b128 v[240:243], v251 offset:43008
    v_exp_f32 v148, v148
    v_exp_f32 v149, v149
    v_mfma_f32_16x16x32_bf16 v[40:43], v[228:231], v[196:199], v[40:43]
    v_cvt_pk_bf16_f32 v27, v146, v147
    v_exp_f32 v150, v150
    v_mfma_f32_16x16x32_bf16 v[44:47], v[228:231], v[220:223], v[44:47]
    v_exp_f32 v151, v151
    v_cvt_pk_bf16_f32 v30, v148, v149
    v_mfma_f32_16x16x32_bf16 v[36:39], v[232:235], v[176:179], v[36:39]
    ds_read_b128 v[228:231], v250 offset:43136
    v_exp_f32 v152, v152
    v_exp_f32 v153, v153
    v_mfma_f32_16x16x32_bf16 v[40:43], v[232:235], v[200:203], v[40:43]
    v_cvt_pk_bf16_f32 v31, v150, v151
    v_exp_f32 v154, v154
    v_mfma_f32_16x16x32_bf16 v[44:47], v[232:235], v[224:227], v[44:47]
    v_exp_f32 v155, v155
    v_cvt_pk_bf16_f32 v34, v152, v153
    v_cvt_pk_bf16_f32 v35, v154, v155
    s_waitcnt lgkmcnt(1)
    v_mfma_f32_16x16x32_bf16 v[144:147], v[236:239], v[156:159], 0
    ds_read_b128 v[232:235], v251 offset:43136
    v_mfma_f32_16x16x32_bf16 v[148:151], v[236:239], v[180:183], 0
    v_mfma_f32_16x16x32_bf16 v[152:155], v[236:239], v[204:207], 0
    s_add_u32 s34, s27, 6144
    buffer_store_dwordx4 v[104:107], v135, s[20:23], s34 offen offset:256
    v_mfma_f32_16x16x32_bf16 v[144:147], v[240:243], v[160:163], v[144:147]
    ds_read_b128 v[236:239], v250 offset:43264
    v_mfma_f32_16x16x32_bf16 v[148:151], v[240:243], v[184:187], v[148:151]
    v_mfma_f32_16x16x32_bf16 v[152:155], v[240:243], v[208:211], v[152:155]
    s_waitcnt lgkmcnt(1)
    v_mfma_f32_16x16x32_bf16 v[144:147], v[228:231], v[164:167], v[144:147]
    ds_read_b128 v[240:243], v251 offset:43264
    v_fma_f32 v36, v36, s29, -v245
    v_fma_f32 v37, v37, s29, -v245
    v_fma_f32 v38, v38, s29, -v245
    v_fma_f32 v39, v39, s29, -v245
    v_mfma_f32_16x16x32_bf16 v[148:151], v[228:231], v[188:191], v[148:151]
    v_fma_f32 v40, v40, s29, -v247
    v_fma_f32 v41, v41, s29, -v247
    v_fma_f32 v42, v42, s29, -v247
    v_mfma_f32_16x16x32_bf16 v[152:155], v[228:231], v[212:215], v[152:155]
    v_fma_f32 v43, v43, s29, -v247
    v_fma_f32 v44, v44, s29, -v249
    v_fma_f32 v45, v45, s29, -v249
    v_fma_f32 v46, v46, s29, -v249
    v_mfma_f32_16x16x32_bf16 v[144:147], v[232:235], v[168:171], v[144:147]
    v_fma_f32 v47, v47, s29, -v249
    v_exp_f32 v36, v36
    v_mfma_f32_16x16x32_bf16 v[148:151], v[232:235], v[192:195], v[148:151]
    v_exp_f32 v37, v37
    v_exp_f32 v38, v38
    v_mfma_f32_16x16x32_bf16 v[152:155], v[232:235], v[216:219], v[152:155]
    v_exp_f32 v39, v39
    v_cvt_pk_bf16_f32 v36, v36, v37
    s_waitcnt lgkmcnt(0)
    v_mfma_f32_16x16x32_bf16 v[144:147], v[236:239], v[172:175], v[144:147]
    v_exp_f32 v40, v40
    v_exp_f32 v41, v41
    v_mfma_f32_16x16x32_bf16 v[148:151], v[236:239], v[196:199], v[148:151]
    v_cvt_pk_bf16_f32 v37, v38, v39
    v_exp_f32 v42, v42
    v_mfma_f32_16x16x32_bf16 v[152:155], v[236:239], v[220:223], v[152:155]
    v_exp_f32 v43, v43
    v_cvt_pk_bf16_f32 v40, v40, v41
    v_mfma_f32_16x16x32_bf16 v[144:147], v[240:243], v[176:179], v[144:147]
    v_exp_f32 v44, v44
    v_exp_f32 v45, v45
    v_mfma_f32_16x16x32_bf16 v[148:151], v[240:243], v[200:203], v[148:151]
    v_cvt_pk_bf16_f32 v41, v42, v43
    v_exp_f32 v46, v46
    v_mfma_f32_16x16x32_bf16 v[152:155], v[240:243], v[224:227], v[152:155]
    v_exp_f32 v47, v47
    v_cvt_pk_bf16_f32 v44, v44, v45
    v_cvt_pk_bf16_f32 v45, v46, v47
    s_waitcnt vmcnt(6)
    s_barrier
    v_add_u32 v250, 0xc000, v250
    v_add_u32 v251, 0xc000, v251
    ds_read_b128 v[228:231], v250 offset:0
    ds_read_b128 v[232:235], v251 offset:0
    ds_read_b128 v[236:239], v250 offset:128
    s_waitcnt lgkmcnt(1)
    v_mfma_f32_16x16x32_bf16 v[48:51], v[228:231], v[156:159], 0
    ds_read_b128 v[240:243], v251 offset:128
    v_fma_f32 v144, v144, s29, -v245
    v_fma_f32 v145, v145, s29, -v245
    v_mfma_f32_16x16x32_bf16 v[52:55], v[228:231], v[180:183], 0
    v_fma_f32 v146, v146, s29, -v245
    v_fma_f32 v147, v147, s29, -v245
    v_fma_f32 v148, v148, s29, -v247
    v_mfma_f32_16x16x32_bf16 v[56:59], v[228:231], v[204:207], 0
    v_fma_f32 v149, v149, s29, -v247
    v_fma_f32 v150, v150, s29, -v247
    s_add_u32 m0, s30, 122880
    s_add_u32 s31, s24, 122880
    buffer_load_dwordx4 v132, s[12:15], s31 offen offset:0 nt lds
    buffer_load_dwordx4 v133, s[12:15], s31 offen offset:1024 nt lds
    buffer_load_dwordx4 v134, s[12:15], s31 offen offset:2048 nt lds
    v_mfma_f32_16x16x32_bf16 v[48:51], v[232:235], v[160:163], v[48:51]
    ds_read_b128 v[228:231], v250 offset:256
    v_fma_f32 v151, v151, s29, -v247
    v_fma_f32 v152, v152, s29, -v249
    v_mfma_f32_16x16x32_bf16 v[52:55], v[232:235], v[184:187], v[52:55]
    v_fma_f32 v153, v153, s29, -v249
    v_fma_f32 v154, v154, s29, -v249
    v_fma_f32 v155, v155, s29, -v249
    v_mfma_f32_16x16x32_bf16 v[56:59], v[232:235], v[208:211], v[56:59]
    v_exp_f32 v144, v144
    s_waitcnt lgkmcnt(1)
    v_mfma_f32_16x16x32_bf16 v[48:51], v[236:239], v[164:167], v[48:51]
    ds_read_b128 v[232:235], v251 offset:256
    v_exp_f32 v145, v145
    v_mfma_f32_16x16x32_bf16 v[52:55], v[236:239], v[188:191], v[52:55]
    v_exp_f32 v146, v146
    v_mfma_f32_16x16x32_bf16 v[56:59], v[236:239], v[212:215], v[56:59]
    v_exp_f32 v147, v147
    v_cvt_pk_bf16_f32 v38, v144, v145
    v_mfma_f32_16x16x32_bf16 v[48:51], v[240:243], v[168:171], v[48:51]
    ds_read_b128 v[236:239], v250 offset:6144
    v_exp_f32 v148, v148
    v_mfma_f32_16x16x32_bf16 v[52:55], v[240:243], v[192:195], v[52:55]
    v_exp_f32 v149, v149
    v_cvt_pk_bf16_f32 v39, v146, v147
    v_mfma_f32_16x16x32_bf16 v[56:59], v[240:243], v[216:219], v[56:59]
    v_exp_f32 v150, v150
    s_waitcnt lgkmcnt(1)
    v_mfma_f32_16x16x32_bf16 v[48:51], v[228:231], v[172:175], v[48:51]
    ds_read_b128 v[240:243], v251 offset:6144
    v_exp_f32 v151, v151
    v_mfma_f32_16x16x32_bf16 v[52:55], v[228:231], v[196:199], v[52:55]
    v_cvt_pk_bf16_f32 v42, v148, v149
    v_exp_f32 v152, v152
    v_mfma_f32_16x16x32_bf16 v[56:59], v[228:231], v[220:223], v[56:59]
    v_exp_f32 v153, v153
    v_mfma_f32_16x16x32_bf16 v[48:51], v[232:235], v[176:179], v[48:51]
    ds_read_b128 v[228:231], v250 offset:6272
    v_cvt_pk_bf16_f32 v43, v150, v151
    v_exp_f32 v154, v154
    v_mfma_f32_16x16x32_bf16 v[52:55], v[232:235], v[200:203], v[52:55]
    v_exp_f32 v155, v155
    v_mfma_f32_16x16x32_bf16 v[56:59], v[232:235], v[224:227], v[56:59]
    v_cvt_pk_bf16_f32 v46, v152, v153
    v_cvt_pk_bf16_f32 v47, v154, v155
    s_waitcnt lgkmcnt(1)
    v_mfma_f32_16x16x32_bf16 v[144:147], v[236:239], v[156:159], 0
    ds_read_b128 v[232:235], v251 offset:6272
    v_mfma_f32_16x16x32_bf16 v[148:151], v[236:239], v[180:183], 0
    v_mfma_f32_16x16x32_bf16 v[152:155], v[236:239], v[204:207], 0
    s_add_u32 s34, s27, 6144
    buffer_store_dwordx4 v[108:111], v135, s[20:23], s34 offen offset:3328
    v_mfma_f32_16x16x32_bf16 v[144:147], v[240:243], v[160:163], v[144:147]
    ds_read_b128 v[236:239], v250 offset:6400
    v_mfma_f32_16x16x32_bf16 v[148:151], v[240:243], v[184:187], v[148:151]
    v_mfma_f32_16x16x32_bf16 v[152:155], v[240:243], v[208:211], v[152:155]
    s_waitcnt lgkmcnt(1)
    v_mfma_f32_16x16x32_bf16 v[144:147], v[228:231], v[164:167], v[144:147]
    ds_read_b128 v[240:243], v251 offset:6400
    v_fma_f32 v48, v48, s29, -v245
    v_fma_f32 v49, v49, s29, -v245
    v_fma_f32 v50, v50, s29, -v245
    v_fma_f32 v51, v51, s29, -v245
    v_mfma_f32_16x16x32_bf16 v[148:151], v[228:231], v[188:191], v[148:151]
    v_fma_f32 v52, v52, s29, -v247
    v_fma_f32 v53, v53, s29, -v247
    v_fma_f32 v54, v54, s29, -v247
    v_mfma_f32_16x16x32_bf16 v[152:155], v[228:231], v[212:215], v[152:155]
    v_fma_f32 v55, v55, s29, -v247
    v_fma_f32 v56, v56, s29, -v249
    v_fma_f32 v57, v57, s29, -v249
    v_fma_f32 v58, v58, s29, -v249
    v_mfma_f32_16x16x32_bf16 v[144:147], v[232:235], v[168:171], v[144:147]
    ds_read_b128 v[228:231], v250 offset:12288
    v_fma_f32 v59, v59, s29, -v249
    v_exp_f32 v48, v48
    v_mfma_f32_16x16x32_bf16 v[148:151], v[232:235], v[192:195], v[148:151]
    v_exp_f32 v49, v49
    v_exp_f32 v50, v50
    v_mfma_f32_16x16x32_bf16 v[152:155], v[232:235], v[216:219], v[152:155]
    v_exp_f32 v51, v51
    v_cvt_pk_bf16_f32 v48, v48, v49
    s_waitcnt lgkmcnt(1)
    v_mfma_f32_16x16x32_bf16 v[144:147], v[236:239], v[172:175], v[144:147]
    ds_read_b128 v[232:235], v251 offset:12288
    v_exp_f32 v52, v52
    v_exp_f32 v53, v53
    v_mfma_f32_16x16x32_bf16 v[148:151], v[236:239], v[196:199], v[148:151]
    v_cvt_pk_bf16_f32 v49, v50, v51
    v_exp_f32 v54, v54
    v_mfma_f32_16x16x32_bf16 v[152:155], v[236:239], v[220:223], v[152:155]
    v_exp_f32 v55, v55
    v_cvt_pk_bf16_f32 v52, v52, v53
    v_mfma_f32_16x16x32_bf16 v[144:147], v[240:243], v[176:179], v[144:147]
    ds_read_b128 v[236:239], v250 offset:12416
    v_exp_f32 v56, v56
    v_exp_f32 v57, v57
    v_mfma_f32_16x16x32_bf16 v[148:151], v[240:243], v[200:203], v[148:151]
    v_cvt_pk_bf16_f32 v53, v54, v55
    v_exp_f32 v58, v58
    v_mfma_f32_16x16x32_bf16 v[152:155], v[240:243], v[224:227], v[152:155]
    v_exp_f32 v59, v59
    v_cvt_pk_bf16_f32 v56, v56, v57
    v_cvt_pk_bf16_f32 v57, v58, v59
    s_waitcnt lgkmcnt(1)
    v_mfma_f32_16x16x32_bf16 v[60:63], v[228:231], v[156:159], 0
    ds_read_b128 v[240:243], v251 offset:12416
    v_mfma_f32_16x16x32_bf16 v[64:67], v[228:231], v[180:183], 0
    v_mfma_f32_16x16x32_bf16 v[68:71], v[228:231], v[204:207], 0
    s_add_u32 s34, s27, 12288
    buffer_store_dwordx4 v[112:115], v135, s[20:23], s34 offen offset:256
    v_mfma_f32_16x16x32_bf16 v[60:63], v[232:235], v[160:163], v[60:63]
    ds_read_b128 v[228:231], v250 offset:12544
    v_mfma_f32_16x16x32_bf16 v[64:67], v[232:235], v[184:187], v[64:67]
    v_mfma_f32_16x16x32_bf16 v[68:71], v[232:235], v[208:211], v[68:71]
    s_waitcnt lgkmcnt(1)
    v_mfma_f32_16x16x32_bf16 v[60:63], v[236:239], v[164:167], v[60:63]
    ds_read_b128 v[232:235], v251 offset:12544
    v_fma_f32 v144, v144, s29, -v245
    v_fma_f32 v145, v145, s29, -v245
    v_fma_f32 v146, v146, s29, -v245
    v_fma_f32 v147, v147, s29, -v245
    v_mfma_f32_16x16x32_bf16 v[64:67], v[236:239], v[188:191], v[64:67]
    v_fma_f32 v148, v148, s29, -v247
    v_fma_f32 v149, v149, s29, -v247
    v_fma_f32 v150, v150, s29, -v247
    v_mfma_f32_16x16x32_bf16 v[68:71], v[236:239], v[212:215], v[68:71]
    v_fma_f32 v151, v151, s29, -v247
    v_fma_f32 v152, v152, s29, -v249
    v_fma_f32 v153, v153, s29, -v249
    v_fma_f32 v154, v154, s29, -v249
    v_mfma_f32_16x16x32_bf16 v[60:63], v[240:243], v[168:171], v[60:63]
    ds_read_b128 v[236:239], v250 offset:18432
    v_fma_f32 v155, v155, s29, -v249
    v_exp_f32 v144, v144
    v_mfma_f32_16x16x32_bf16 v[64:67], v[240:243], v[192:195], v[64:67]
    v_exp_f32 v145, v145
    v_exp_f32 v146, v146
    v_mfma_f32_16x16x32_bf16 v[68:71], v[240:243], v[216:219], v[68:71]
    v_exp_f32 v147, v147
    v_cvt_pk_bf16_f32 v50, v144, v145
    s_waitcnt lgkmcnt(1)
    v_mfma_f32_16x16x32_bf16 v[60:63], v[228:231], v[172:175], v[60:63]
    ds_read_b128 v[240:243], v251 offset:18432
    v_exp_f32 v148, v148
    v_exp_f32 v149, v149
    v_mfma_f32_16x16x32_bf16 v[64:67], v[228:231], v[196:199], v[64:67]
    v_cvt_pk_bf16_f32 v51, v146, v147
    v_exp_f32 v150, v150
    v_mfma_f32_16x16x32_bf16 v[68:71], v[228:231], v[220:223], v[68:71]
    v_exp_f32 v151, v151
    v_cvt_pk_bf16_f32 v54, v148, v149
    v_mfma_f32_16x16x32_bf16 v[60:63], v[232:235], v[176:179], v[60:63]
    ds_read_b128 v[228:231], v250 offset:18560
    v_exp_f32 v152, v152
    v_exp_f32 v153, v153
    v_mfma_f32_16x16x32_bf16 v[64:67], v[232:235], v[200:203], v[64:67]
    v_cvt_pk_bf16_f32 v55, v150, v151
    v_exp_f32 v154, v154
    v_mfma_f32_16x16x32_bf16 v[68:71], v[232:235], v[224:227], v[68:71]
    v_exp_f32 v155, v155
    v_cvt_pk_bf16_f32 v58, v152, v153
    v_cvt_pk_bf16_f32 v59, v154, v155
    s_waitcnt lgkmcnt(1)
    v_mfma_f32_16x16x32_bf16 v[144:147], v[236:239], v[156:159], 0
    ds_read_b128 v[232:235], v251 offset:18560
    v_mfma_f32_16x16x32_bf16 v[148:151], v[236:239], v[180:183], 0
    v_mfma_f32_16x16x32_bf16 v[152:155], v[236:239], v[204:207], 0
    s_add_u32 s34, s27, 12288
    buffer_store_dwordx4 v[116:119], v135, s[20:23], s34 offen offset:3328
    v_mfma_f32_16x16x32_bf16 v[144:147], v[240:243], v[160:163], v[144:147]
    ds_read_b128 v[236:239], v250 offset:18688
    v_mfma_f32_16x16x32_bf16 v[148:151], v[240:243], v[184:187], v[148:151]
    v_mfma_f32_16x16x32_bf16 v[152:155], v[240:243], v[208:211], v[152:155]
    s_waitcnt lgkmcnt(1)
    v_mfma_f32_16x16x32_bf16 v[144:147], v[228:231], v[164:167], v[144:147]
    ds_read_b128 v[240:243], v251 offset:18688
    v_fma_f32 v60, v60, s29, -v245
    v_fma_f32 v61, v61, s29, -v245
    v_fma_f32 v62, v62, s29, -v245
    v_fma_f32 v63, v63, s29, -v245
    v_mfma_f32_16x16x32_bf16 v[148:151], v[228:231], v[188:191], v[148:151]
    v_fma_f32 v64, v64, s29, -v247
    v_fma_f32 v65, v65, s29, -v247
    v_fma_f32 v66, v66, s29, -v247
    v_mfma_f32_16x16x32_bf16 v[152:155], v[228:231], v[212:215], v[152:155]
    v_fma_f32 v67, v67, s29, -v247
    v_fma_f32 v68, v68, s29, -v249
    v_fma_f32 v69, v69, s29, -v249
    v_fma_f32 v70, v70, s29, -v249
    v_mfma_f32_16x16x32_bf16 v[144:147], v[232:235], v[168:171], v[144:147]
    ds_read_b128 v[228:231], v250 offset:24576
    v_fma_f32 v71, v71, s29, -v249
    v_exp_f32 v60, v60
    v_mfma_f32_16x16x32_bf16 v[148:151], v[232:235], v[192:195], v[148:151]
    v_exp_f32 v61, v61
    v_exp_f32 v62, v62
    v_mfma_f32_16x16x32_bf16 v[152:155], v[232:235], v[216:219], v[152:155]
    v_exp_f32 v63, v63
    v_cvt_pk_bf16_f32 v60, v60, v61
    s_waitcnt lgkmcnt(1)
    v_mfma_f32_16x16x32_bf16 v[144:147], v[236:239], v[172:175], v[144:147]
    ds_read_b128 v[232:235], v251 offset:24576
    v_exp_f32 v64, v64
    v_exp_f32 v65, v65
    v_mfma_f32_16x16x32_bf16 v[148:151], v[236:239], v[196:199], v[148:151]
    v_cvt_pk_bf16_f32 v61, v62, v63
    v_exp_f32 v66, v66
    v_mfma_f32_16x16x32_bf16 v[152:155], v[236:239], v[220:223], v[152:155]
    v_exp_f32 v67, v67
    v_cvt_pk_bf16_f32 v64, v64, v65
    v_mfma_f32_16x16x32_bf16 v[144:147], v[240:243], v[176:179], v[144:147]
    ds_read_b128 v[236:239], v250 offset:24704
    v_exp_f32 v68, v68
    v_exp_f32 v69, v69
    v_mfma_f32_16x16x32_bf16 v[148:151], v[240:243], v[200:203], v[148:151]
    v_cvt_pk_bf16_f32 v65, v66, v67
    v_exp_f32 v70, v70
    v_mfma_f32_16x16x32_bf16 v[152:155], v[240:243], v[224:227], v[152:155]
    v_exp_f32 v71, v71
    v_cvt_pk_bf16_f32 v68, v68, v69
    v_cvt_pk_bf16_f32 v69, v70, v71
    s_waitcnt vmcnt(9)
    s_barrier
    s_waitcnt lgkmcnt(1)
    v_mfma_f32_16x16x32_bf16 v[72:75], v[228:231], v[156:159], 0
    ds_read_b128 v[240:243], v251 offset:24704
    v_mfma_f32_16x16x32_bf16 v[76:79], v[228:231], v[180:183], 0
    v_mfma_f32_16x16x32_bf16 v[80:83], v[228:231], v[204:207], 0
    s_add_u32 m0, s30, 0
    s_add_u32 s31, s24, 0
    buffer_load_dwordx4 v252, s[16:19], s31 offen offset:0 nt lds
    s_add_u32 s31, s24, 2048
    buffer_load_dwordx4 v252, s[16:19], s31 offen offset:1024 nt lds
    s_add_u32 s31, s24, 4096
    buffer_load_dwordx4 v252, s[16:19], s31 offen offset:2048 nt lds
    v_mfma_f32_16x16x32_bf16 v[72:75], v[232:235], v[160:163], v[72:75]
    ds_read_b128 v[228:231], v250 offset:24832
    v_mfma_f32_16x16x32_bf16 v[76:79], v[232:235], v[184:187], v[76:79]
    v_mfma_f32_16x16x32_bf16 v[80:83], v[232:235], v[208:211], v[80:83]
    s_waitcnt lgkmcnt(1)
    v_mfma_f32_16x16x32_bf16 v[72:75], v[236:239], v[164:167], v[72:75]
    ds_read_b128 v[232:235], v251 offset:24832
    v_fma_f32 v144, v144, s29, -v245
    v_fma_f32 v145, v145, s29, -v245
    v_fma_f32 v146, v146, s29, -v245
    v_fma_f32 v147, v147, s29, -v245
    v_mfma_f32_16x16x32_bf16 v[76:79], v[236:239], v[188:191], v[76:79]
    v_fma_f32 v148, v148, s29, -v247
    v_fma_f32 v149, v149, s29, -v247
    v_fma_f32 v150, v150, s29, -v247
    v_mfma_f32_16x16x32_bf16 v[80:83], v[236:239], v[212:215], v[80:83]
    v_fma_f32 v151, v151, s29, -v247
    v_fma_f32 v152, v152, s29, -v249
    v_fma_f32 v153, v153, s29, -v249
    v_fma_f32 v154, v154, s29, -v249
    v_mfma_f32_16x16x32_bf16 v[72:75], v[240:243], v[168:171], v[72:75]
    ds_read_b128 v[236:239], v250 offset:30720
    v_fma_f32 v155, v155, s29, -v249
    v_exp_f32 v144, v144
    v_mfma_f32_16x16x32_bf16 v[76:79], v[240:243], v[192:195], v[76:79]
    v_exp_f32 v145, v145
    v_exp_f32 v146, v146
    v_mfma_f32_16x16x32_bf16 v[80:83], v[240:243], v[216:219], v[80:83]
    v_exp_f32 v147, v147
    v_cvt_pk_bf16_f32 v62, v144, v145
    s_waitcnt lgkmcnt(1)
    v_mfma_f32_16x16x32_bf16 v[72:75], v[228:231], v[172:175], v[72:75]
    ds_read_b128 v[240:243], v251 offset:30720
    v_exp_f32 v148, v148
    v_exp_f32 v149, v149
    v_mfma_f32_16x16x32_bf16 v[76:79], v[228:231], v[196:199], v[76:79]
    v_cvt_pk_bf16_f32 v63, v146, v147
    v_exp_f32 v150, v150
    v_mfma_f32_16x16x32_bf16 v[80:83], v[228:231], v[220:223], v[80:83]
    v_exp_f32 v151, v151
    v_cvt_pk_bf16_f32 v66, v148, v149
    v_mfma_f32_16x16x32_bf16 v[72:75], v[232:235], v[176:179], v[72:75]
    ds_read_b128 v[228:231], v250 offset:30848
    v_exp_f32 v152, v152
    v_exp_f32 v153, v153
    v_mfma_f32_16x16x32_bf16 v[76:79], v[232:235], v[200:203], v[76:79]
    v_cvt_pk_bf16_f32 v67, v150, v151
    v_exp_f32 v154, v154
    v_mfma_f32_16x16x32_bf16 v[80:83], v[232:235], v[224:227], v[80:83]
    v_exp_f32 v155, v155
    v_cvt_pk_bf16_f32 v70, v152, v153
    v_cvt_pk_bf16_f32 v71, v154, v155
    s_waitcnt lgkmcnt(1)
    v_mfma_f32_16x16x32_bf16 v[144:147], v[236:239], v[156:159], 0
    ds_read_b128 v[232:235], v251 offset:30848
    v_mfma_f32_16x16x32_bf16 v[148:151], v[236:239], v[180:183], 0
    v_mfma_f32_16x16x32_bf16 v[152:155], v[236:239], v[204:207], 0
    s_add_u32 s34, s27, 6144
    buffer_store_dwordx4 v[120:123], v135, s[20:23], s34 offen offset:3200
    v_mfma_f32_16x16x32_bf16 v[144:147], v[240:243], v[160:163], v[144:147]
    ds_read_b128 v[236:239], v250 offset:30976
    v_mfma_f32_16x16x32_bf16 v[148:151], v[240:243], v[184:187], v[148:151]
    v_mfma_f32_16x16x32_bf16 v[152:155], v[240:243], v[208:211], v[152:155]
    s_waitcnt lgkmcnt(1)
    v_mfma_f32_16x16x32_bf16 v[144:147], v[228:231], v[164:167], v[144:147]
    ds_read_b128 v[240:243], v251 offset:30976
    v_fma_f32 v72, v72, s29, -v245
    v_fma_f32 v73, v73, s29, -v245
    v_fma_f32 v74, v74, s29, -v245
    v_fma_f32 v75, v75, s29, -v245
    v_mfma_f32_16x16x32_bf16 v[148:151], v[228:231], v[188:191], v[148:151]
    v_fma_f32 v76, v76, s29, -v247
    v_fma_f32 v77, v77, s29, -v247
    v_fma_f32 v78, v78, s29, -v247
    v_mfma_f32_16x16x32_bf16 v[152:155], v[228:231], v[212:215], v[152:155]
    v_fma_f32 v79, v79, s29, -v247
    v_fma_f32 v80, v80, s29, -v249
    v_fma_f32 v81, v81, s29, -v249
    v_fma_f32 v82, v82, s29, -v249
    v_mfma_f32_16x16x32_bf16 v[144:147], v[232:235], v[168:171], v[144:147]
    ds_read_b128 v[228:231], v250 offset:36864
    v_fma_f32 v83, v83, s29, -v249
    v_exp_f32 v72, v72
    v_mfma_f32_16x16x32_bf16 v[148:151], v[232:235], v[192:195], v[148:151]
    v_exp_f32 v73, v73
    v_exp_f32 v74, v74
    v_mfma_f32_16x16x32_bf16 v[152:155], v[232:235], v[216:219], v[152:155]
    v_exp_f32 v75, v75
    v_cvt_pk_bf16_f32 v72, v72, v73
    s_waitcnt lgkmcnt(1)
    v_mfma_f32_16x16x32_bf16 v[144:147], v[236:239], v[172:175], v[144:147]
    ds_read_b128 v[232:235], v251 offset:36864
    v_exp_f32 v76, v76
    v_exp_f32 v77, v77
    v_mfma_f32_16x16x32_bf16 v[148:151], v[236:239], v[196:199], v[148:151]
    v_cvt_pk_bf16_f32 v73, v74, v75
    v_exp_f32 v78, v78
    v_mfma_f32_16x16x32_bf16 v[152:155], v[236:239], v[220:223], v[152:155]
    v_exp_f32 v79, v79
    v_cvt_pk_bf16_f32 v76, v76, v77
    v_mfma_f32_16x16x32_bf16 v[144:147], v[240:243], v[176:179], v[144:147]
    ds_read_b128 v[236:239], v250 offset:36992
    v_exp_f32 v80, v80
    v_exp_f32 v81, v81
    v_mfma_f32_16x16x32_bf16 v[148:151], v[240:243], v[200:203], v[148:151]
    v_cvt_pk_bf16_f32 v77, v78, v79
    v_exp_f32 v82, v82
    v_mfma_f32_16x16x32_bf16 v[152:155], v[240:243], v[224:227], v[152:155]
    v_exp_f32 v83, v83
    v_cvt_pk_bf16_f32 v80, v80, v81
    v_cvt_pk_bf16_f32 v81, v82, v83
    s_waitcnt lgkmcnt(1)
    v_mfma_f32_16x16x32_bf16 v[84:87], v[228:231], v[156:159], 0
    ds_read_b128 v[240:243], v251 offset:36992
    v_mfma_f32_16x16x32_bf16 v[88:91], v[228:231], v[180:183], 0
    v_mfma_f32_16x16x32_bf16 v[92:95], v[228:231], v[204:207], 0
    s_add_u32 s34, s27, 12288
    buffer_store_dwordx4 v[124:127], v135, s[20:23], s34 offen offset:128
    v_mfma_f32_16x16x32_bf16 v[84:87], v[232:235], v[160:163], v[84:87]
    ds_read_b128 v[228:231], v250 offset:37120
    v_mfma_f32_16x16x32_bf16 v[88:91], v[232:235], v[184:187], v[88:91]
    v_mfma_f32_16x16x32_bf16 v[92:95], v[232:235], v[208:211], v[92:95]
    s_waitcnt lgkmcnt(1)
    v_mfma_f32_16x16x32_bf16 v[84:87], v[236:239], v[164:167], v[84:87]
    ds_read_b128 v[232:235], v251 offset:37120
    v_fma_f32 v144, v144, s29, -v245
    v_fma_f32 v145, v145, s29, -v245
    v_fma_f32 v146, v146, s29, -v245
    v_fma_f32 v147, v147, s29, -v245
    v_mfma_f32_16x16x32_bf16 v[88:91], v[236:239], v[188:191], v[88:91]
    v_fma_f32 v148, v148, s29, -v247
    v_fma_f32 v149, v149, s29, -v247
    v_fma_f32 v150, v150, s29, -v247
    v_mfma_f32_16x16x32_bf16 v[92:95], v[236:239], v[212:215], v[92:95]
    v_fma_f32 v151, v151, s29, -v247
    v_fma_f32 v152, v152, s29, -v249
    v_fma_f32 v153, v153, s29, -v249
    v_fma_f32 v154, v154, s29, -v249
    v_mfma_f32_16x16x32_bf16 v[84:87], v[240:243], v[168:171], v[84:87]
    ds_read_b128 v[236:239], v250 offset:43008
    v_fma_f32 v155, v155, s29, -v249
    v_exp_f32 v144, v144
    v_mfma_f32_16x16x32_bf16 v[88:91], v[240:243], v[192:195], v[88:91]
    v_exp_f32 v145, v145
    v_exp_f32 v146, v146
    v_mfma_f32_16x16x32_bf16 v[92:95], v[240:243], v[216:219], v[92:95]
    v_exp_f32 v147, v147
    v_cvt_pk_bf16_f32 v74, v144, v145
    s_waitcnt lgkmcnt(1)
    v_mfma_f32_16x16x32_bf16 v[84:87], v[228:231], v[172:175], v[84:87]
    ds_read_b128 v[240:243], v251 offset:43008
    v_exp_f32 v148, v148
    v_exp_f32 v149, v149
    v_mfma_f32_16x16x32_bf16 v[88:91], v[228:231], v[196:199], v[88:91]
    v_cvt_pk_bf16_f32 v75, v146, v147
    v_exp_f32 v150, v150
    v_mfma_f32_16x16x32_bf16 v[92:95], v[228:231], v[220:223], v[92:95]
    v_exp_f32 v151, v151
    v_cvt_pk_bf16_f32 v78, v148, v149
    v_mfma_f32_16x16x32_bf16 v[84:87], v[232:235], v[176:179], v[84:87]
    ds_read_b128 v[228:231], v250 offset:43136
    v_exp_f32 v152, v152
    v_exp_f32 v153, v153
    v_mfma_f32_16x16x32_bf16 v[88:91], v[232:235], v[200:203], v[88:91]
    v_cvt_pk_bf16_f32 v79, v150, v151
    v_exp_f32 v154, v154
    v_mfma_f32_16x16x32_bf16 v[92:95], v[232:235], v[224:227], v[92:95]
    v_exp_f32 v155, v155
    v_cvt_pk_bf16_f32 v82, v152, v153
    v_cvt_pk_bf16_f32 v83, v154, v155
    s_waitcnt lgkmcnt(1)
    v_mfma_f32_16x16x32_bf16 v[144:147], v[236:239], v[156:159], 0
    ds_read_b128 v[232:235], v251 offset:43136
    v_mfma_f32_16x16x32_bf16 v[148:151], v[236:239], v[180:183], 0
    v_mfma_f32_16x16x32_bf16 v[152:155], v[236:239], v[204:207], 0
    s_add_u32 s34, s27, 12288
    buffer_store_dwordx4 v[128:131], v135, s[20:23], s34 offen offset:3200
    v_mfma_f32_16x16x32_bf16 v[144:147], v[240:243], v[160:163], v[144:147]
    ds_read_b128 v[236:239], v250 offset:43264
    v_mfma_f32_16x16x32_bf16 v[148:151], v[240:243], v[184:187], v[148:151]
    v_mfma_f32_16x16x32_bf16 v[152:155], v[240:243], v[208:211], v[152:155]
    s_waitcnt lgkmcnt(1)
    v_mfma_f32_16x16x32_bf16 v[144:147], v[228:231], v[164:167], v[144:147]
    ds_read_b128 v[240:243], v251 offset:43264
    v_fma_f32 v84, v84, s29, -v245
    v_fma_f32 v85, v85, s29, -v245
    v_fma_f32 v86, v86, s29, -v245
    v_fma_f32 v87, v87, s29, -v245
    v_mfma_f32_16x16x32_bf16 v[148:151], v[228:231], v[188:191], v[148:151]
    v_fma_f32 v88, v88, s29, -v247
    v_fma_f32 v89, v89, s29, -v247
    v_fma_f32 v90, v90, s29, -v247
    v_mfma_f32_16x16x32_bf16 v[152:155], v[228:231], v[212:215], v[152:155]
    v_fma_f32 v91, v91, s29, -v247
    v_fma_f32 v92, v92, s29, -v249
    v_fma_f32 v93, v93, s29, -v249
    v_fma_f32 v94, v94, s29, -v249
    v_mfma_f32_16x16x32_bf16 v[144:147], v[232:235], v[168:171], v[144:147]
    v_add_u32 v250, 0xc000, v250
    v_add_u32 v251, 0xc000, v251
    ds_read_b128 v[228:231], v250 offset:0
    v_fma_f32 v95, v95, s29, -v249
    v_exp_f32 v84, v84
    v_mfma_f32_16x16x32_bf16 v[148:151], v[232:235], v[192:195], v[148:151]
    v_exp_f32 v85, v85
    v_exp_f32 v86, v86
    v_mfma_f32_16x16x32_bf16 v[152:155], v[232:235], v[216:219], v[152:155]
    v_exp_f32 v87, v87
    v_cvt_pk_bf16_f32 v84, v84, v85
    s_waitcnt lgkmcnt(1)
    v_mfma_f32_16x16x32_bf16 v[144:147], v[236:239], v[172:175], v[144:147]
    ds_read_b128 v[232:235], v251 offset:0
    v_exp_f32 v88, v88
    v_exp_f32 v89, v89
    v_mfma_f32_16x16x32_bf16 v[148:151], v[236:239], v[196:199], v[148:151]
    v_cvt_pk_bf16_f32 v85, v86, v87
    v_exp_f32 v90, v90
    v_mfma_f32_16x16x32_bf16 v[152:155], v[236:239], v[220:223], v[152:155]
    v_exp_f32 v91, v91
    v_cvt_pk_bf16_f32 v88, v88, v89
    v_mfma_f32_16x16x32_bf16 v[144:147], v[240:243], v[176:179], v[144:147]
    ds_read_b128 v[236:239], v250 offset:128
    v_exp_f32 v92, v92
    v_exp_f32 v93, v93
    v_mfma_f32_16x16x32_bf16 v[148:151], v[240:243], v[200:203], v[148:151]
    v_cvt_pk_bf16_f32 v89, v90, v91
    v_exp_f32 v94, v94
    v_mfma_f32_16x16x32_bf16 v[152:155], v[240:243], v[224:227], v[152:155]
    v_exp_f32 v95, v95
    v_cvt_pk_bf16_f32 v92, v92, v93
    v_cvt_pk_bf16_f32 v93, v94, v95
    s_waitcnt vmcnt(9)
    s_barrier
    s_waitcnt lgkmcnt(1)
    v_mfma_f32_16x16x32_bf16 v[96:99], v[228:231], v[156:159], 0
    ds_read_b128 v[240:243], v251 offset:128
    v_mfma_f32_16x16x32_bf16 v[100:103], v[228:231], v[180:183], 0
    v_mfma_f32_16x16x32_bf16 v[104:107], v[228:231], v[204:207], 0
    s_add_u32 m0, s30, 49152
    s_add_u32 s31, s24, 73728
    buffer_load_dwordx4 v252, s[16:19], s31 offen offset:0 nt lds
    s_add_u32 s31, s24, 75776
    buffer_load_dwordx4 v252, s[16:19], s31 offen offset:1024 nt lds
    s_add_u32 s31, s24, 77824
    buffer_load_dwordx4 v252, s[16:19], s31 offen offset:2048 nt lds
    v_mfma_f32_16x16x32_bf16 v[96:99], v[232:235], v[160:163], v[96:99]
    ds_read_b128 v[228:231], v250 offset:256
    v_mfma_f32_16x16x32_bf16 v[100:103], v[232:235], v[184:187], v[100:103]
    v_mfma_f32_16x16x32_bf16 v[104:107], v[232:235], v[208:211], v[104:107]
    s_waitcnt lgkmcnt(1)
    v_mfma_f32_16x16x32_bf16 v[96:99], v[236:239], v[164:167], v[96:99]
    ds_read_b128 v[232:235], v251 offset:256
    v_fma_f32 v144, v144, s29, -v245
    v_fma_f32 v145, v145, s29, -v245
    v_fma_f32 v146, v146, s29, -v245
    v_fma_f32 v147, v147, s29, -v245
    v_mfma_f32_16x16x32_bf16 v[100:103], v[236:239], v[188:191], v[100:103]
    v_fma_f32 v148, v148, s29, -v247
    v_fma_f32 v149, v149, s29, -v247
    v_fma_f32 v150, v150, s29, -v247
    v_mfma_f32_16x16x32_bf16 v[104:107], v[236:239], v[212:215], v[104:107]
    v_fma_f32 v151, v151, s29, -v247
    v_fma_f32 v152, v152, s29, -v249
    v_fma_f32 v153, v153, s29, -v249
    v_fma_f32 v154, v154, s29, -v249
    v_mfma_f32_16x16x32_bf16 v[96:99], v[240:243], v[168:171], v[96:99]
    ds_read_b128 v[236:239], v250 offset:6144
    v_fma_f32 v155, v155, s29, -v249
    v_exp_f32 v144, v144
    v_mfma_f32_16x16x32_bf16 v[100:103], v[240:243], v[192:195], v[100:103]
    v_exp_f32 v145, v145
    v_exp_f32 v146, v146
    v_mfma_f32_16x16x32_bf16 v[104:107], v[240:243], v[216:219], v[104:107]
    v_exp_f32 v147, v147
    v_cvt_pk_bf16_f32 v86, v144, v145
    s_waitcnt lgkmcnt(1)
    v_mfma_f32_16x16x32_bf16 v[96:99], v[228:231], v[172:175], v[96:99]
    ds_read_b128 v[240:243], v251 offset:6144
    v_exp_f32 v148, v148
    v_exp_f32 v149, v149
    v_mfma_f32_16x16x32_bf16 v[100:103], v[228:231], v[196:199], v[100:103]
    v_cvt_pk_bf16_f32 v87, v146, v147
    v_exp_f32 v150, v150
    v_mfma_f32_16x16x32_bf16 v[104:107], v[228:231], v[220:223], v[104:107]
    v_exp_f32 v151, v151
    v_cvt_pk_bf16_f32 v90, v148, v149
    v_mfma_f32_16x16x32_bf16 v[96:99], v[232:235], v[176:179], v[96:99]
    ds_read_b128 v[228:231], v250 offset:6272
    v_exp_f32 v152, v152
    v_exp_f32 v153, v153
    v_mfma_f32_16x16x32_bf16 v[100:103], v[232:235], v[200:203], v[100:103]
    v_cvt_pk_bf16_f32 v91, v150, v151
    v_exp_f32 v154, v154
    v_mfma_f32_16x16x32_bf16 v[104:107], v[232:235], v[224:227], v[104:107]
    v_exp_f32 v155, v155
    v_cvt_pk_bf16_f32 v94, v152, v153
    v_cvt_pk_bf16_f32 v95, v154, v155
    s_waitcnt lgkmcnt(1)
    v_mfma_f32_16x16x32_bf16 v[144:147], v[236:239], v[156:159], 0
    ds_read_b128 v[232:235], v251 offset:6272
    v_mfma_f32_16x16x32_bf16 v[148:151], v[236:239], v[180:183], 0
    v_mfma_f32_16x16x32_bf16 v[152:155], v[236:239], v[204:207], 0
    v_mfma_f32_16x16x32_bf16 v[144:147], v[240:243], v[160:163], v[144:147]
    ds_read_b128 v[236:239], v250 offset:6400
    v_mfma_f32_16x16x32_bf16 v[148:151], v[240:243], v[184:187], v[148:151]
    v_mfma_f32_16x16x32_bf16 v[152:155], v[240:243], v[208:211], v[152:155]
    s_waitcnt lgkmcnt(1)
    v_mfma_f32_16x16x32_bf16 v[144:147], v[228:231], v[164:167], v[144:147]
    ds_read_b128 v[240:243], v251 offset:6400
    v_fma_f32 v96, v96, s29, -v245
    v_fma_f32 v97, v97, s29, -v245
    v_fma_f32 v98, v98, s29, -v245
    v_fma_f32 v99, v99, s29, -v245
    v_mfma_f32_16x16x32_bf16 v[148:151], v[228:231], v[188:191], v[148:151]
    v_fma_f32 v100, v100, s29, -v247
    v_fma_f32 v101, v101, s29, -v247
    v_fma_f32 v102, v102, s29, -v247
    v_mfma_f32_16x16x32_bf16 v[152:155], v[228:231], v[212:215], v[152:155]
    v_fma_f32 v103, v103, s29, -v247
    v_fma_f32 v104, v104, s29, -v249
    v_fma_f32 v105, v105, s29, -v249
    v_fma_f32 v106, v106, s29, -v249
    v_mfma_f32_16x16x32_bf16 v[144:147], v[232:235], v[168:171], v[144:147]
    ds_read_b128 v[228:231], v250 offset:12288
    v_fma_f32 v107, v107, s29, -v249
    v_exp_f32 v96, v96
    v_mfma_f32_16x16x32_bf16 v[148:151], v[232:235], v[192:195], v[148:151]
    v_exp_f32 v97, v97
    v_exp_f32 v98, v98
    v_mfma_f32_16x16x32_bf16 v[152:155], v[232:235], v[216:219], v[152:155]
    v_exp_f32 v99, v99
    v_cvt_pk_bf16_f32 v96, v96, v97
    s_waitcnt lgkmcnt(1)
    v_mfma_f32_16x16x32_bf16 v[144:147], v[236:239], v[172:175], v[144:147]
    ds_read_b128 v[232:235], v251 offset:12288
    v_exp_f32 v100, v100
    v_exp_f32 v101, v101
    v_mfma_f32_16x16x32_bf16 v[148:151], v[236:239], v[196:199], v[148:151]
    v_cvt_pk_bf16_f32 v97, v98, v99
    v_exp_f32 v102, v102
    v_mfma_f32_16x16x32_bf16 v[152:155], v[236:239], v[220:223], v[152:155]
    v_exp_f32 v103, v103
    v_cvt_pk_bf16_f32 v100, v100, v101
    v_mfma_f32_16x16x32_bf16 v[144:147], v[240:243], v[176:179], v[144:147]
    ds_read_b128 v[236:239], v250 offset:12416
    v_exp_f32 v104, v104
    v_exp_f32 v105, v105
    v_mfma_f32_16x16x32_bf16 v[148:151], v[240:243], v[200:203], v[148:151]
    v_cvt_pk_bf16_f32 v101, v102, v103
    v_exp_f32 v106, v106
    v_mfma_f32_16x16x32_bf16 v[152:155], v[240:243], v[224:227], v[152:155]
    v_exp_f32 v107, v107
    v_cvt_pk_bf16_f32 v104, v104, v105
    v_cvt_pk_bf16_f32 v105, v106, v107
    s_waitcnt lgkmcnt(1)
    v_mfma_f32_16x16x32_bf16 v[108:111], v[228:231], v[156:159], 0
    ds_read_b128 v[240:243], v251 offset:12416
    v_mfma_f32_16x16x32_bf16 v[112:115], v[228:231], v[180:183], 0
    v_mfma_f32_16x16x32_bf16 v[116:119], v[228:231], v[204:207], 0
    s_add_u32 m0, s30, 73728
    s_add_u32 s31, s24, 128
    buffer_load_dwordx4 v252, s[16:19], s31 offen offset:0 nt lds
    s_add_u32 s31, s24, 2176
    buffer_load_dwordx4 v252, s[16:19], s31 offen offset:1024 nt lds
    s_add_u32 s31, s24, 4224
    buffer_load_dwordx4 v252, s[16:19], s31 offen offset:2048 nt lds
    v_mfma_f32_16x16x32_bf16 v[108:111], v[232:235], v[160:163], v[108:111]
    ds_read_b128 v[228:231], v250 offset:12544
    v_mfma_f32_16x16x32_bf16 v[112:115], v[232:235], v[184:187], v[112:115]
    v_mfma_f32_16x16x32_bf16 v[116:119], v[232:235], v[208:211], v[116:119]
    s_waitcnt lgkmcnt(1)
    v_mfma_f32_16x16x32_bf16 v[108:111], v[236:239], v[164:167], v[108:111]
    ds_read_b128 v[232:235], v251 offset:12544
    v_fma_f32 v144, v144, s29, -v245
    v_fma_f32 v145, v145, s29, -v245
    v_fma_f32 v146, v146, s29, -v245
    v_fma_f32 v147, v147, s29, -v245
    v_mfma_f32_16x16x32_bf16 v[112:115], v[236:239], v[188:191], v[112:115]
    v_fma_f32 v148, v148, s29, -v247
    v_fma_f32 v149, v149, s29, -v247
    v_fma_f32 v150, v150, s29, -v247
    v_mfma_f32_16x16x32_bf16 v[116:119], v[236:239], v[212:215], v[116:119]
    v_fma_f32 v151, v151, s29, -v247
    v_fma_f32 v152, v152, s29, -v249
    v_fma_f32 v153, v153, s29, -v249
    v_fma_f32 v154, v154, s29, -v249
    v_mfma_f32_16x16x32_bf16 v[108:111], v[240:243], v[168:171], v[108:111]
    ds_read_b128 v[236:239], v250 offset:18432
    v_fma_f32 v155, v155, s29, -v249
    v_exp_f32 v144, v144
    v_mfma_f32_16x16x32_bf16 v[112:115], v[240:243], v[192:195], v[112:115]
    v_exp_f32 v145, v145
    v_exp_f32 v146, v146
    v_mfma_f32_16x16x32_bf16 v[116:119], v[240:243], v[216:219], v[116:119]
    v_exp_f32 v147, v147
    v_cvt_pk_bf16_f32 v98, v144, v145
    s_waitcnt lgkmcnt(1)
    v_mfma_f32_16x16x32_bf16 v[108:111], v[228:231], v[172:175], v[108:111]
    ds_read_b128 v[240:243], v251 offset:18432
    v_exp_f32 v148, v148
    v_exp_f32 v149, v149
    v_mfma_f32_16x16x32_bf16 v[112:115], v[228:231], v[196:199], v[112:115]
    v_cvt_pk_bf16_f32 v99, v146, v147
    v_exp_f32 v150, v150
    v_mfma_f32_16x16x32_bf16 v[116:119], v[228:231], v[220:223], v[116:119]
    v_exp_f32 v151, v151
    v_cvt_pk_bf16_f32 v102, v148, v149
    v_mfma_f32_16x16x32_bf16 v[108:111], v[232:235], v[176:179], v[108:111]
    ds_read_b128 v[228:231], v250 offset:18560
    v_exp_f32 v152, v152
    v_exp_f32 v153, v153
    v_mfma_f32_16x16x32_bf16 v[112:115], v[232:235], v[200:203], v[112:115]
    v_cvt_pk_bf16_f32 v103, v150, v151
    v_exp_f32 v154, v154
    v_mfma_f32_16x16x32_bf16 v[116:119], v[232:235], v[224:227], v[116:119]
    v_exp_f32 v155, v155
    v_cvt_pk_bf16_f32 v106, v152, v153
    v_cvt_pk_bf16_f32 v107, v154, v155
    s_waitcnt lgkmcnt(1)
    v_mfma_f32_16x16x32_bf16 v[144:147], v[236:239], v[156:159], 0
    ds_read_b128 v[232:235], v251 offset:18560
    v_mfma_f32_16x16x32_bf16 v[148:151], v[236:239], v[180:183], 0
    v_mfma_f32_16x16x32_bf16 v[152:155], v[236:239], v[204:207], 0
    v_mfma_f32_16x16x32_bf16 v[144:147], v[240:243], v[160:163], v[144:147]
    ds_read_b128 v[236:239], v250 offset:18688
    v_mfma_f32_16x16x32_bf16 v[148:151], v[240:243], v[184:187], v[148:151]
    v_mfma_f32_16x16x32_bf16 v[152:155], v[240:243], v[208:211], v[152:155]
    s_waitcnt lgkmcnt(1)
    v_mfma_f32_16x16x32_bf16 v[144:147], v[228:231], v[164:167], v[144:147]
    ds_read_b128 v[240:243], v251 offset:18688
    v_fma_f32 v108, v108, s29, -v245
    v_fma_f32 v109, v109, s29, -v245
    v_fma_f32 v110, v110, s29, -v245
    v_fma_f32 v111, v111, s29, -v245
    v_mfma_f32_16x16x32_bf16 v[148:151], v[228:231], v[188:191], v[148:151]
    v_fma_f32 v112, v112, s29, -v247
    v_fma_f32 v113, v113, s29, -v247
    v_fma_f32 v114, v114, s29, -v247
    v_mfma_f32_16x16x32_bf16 v[152:155], v[228:231], v[212:215], v[152:155]
    v_fma_f32 v115, v115, s29, -v247
    v_fma_f32 v116, v116, s29, -v249
    v_fma_f32 v117, v117, s29, -v249
    v_fma_f32 v118, v118, s29, -v249
    v_mfma_f32_16x16x32_bf16 v[144:147], v[232:235], v[168:171], v[144:147]
    ds_read_b128 v[228:231], v250 offset:24576
    v_fma_f32 v119, v119, s29, -v249
    v_exp_f32 v108, v108
    v_mfma_f32_16x16x32_bf16 v[148:151], v[232:235], v[192:195], v[148:151]
    v_exp_f32 v109, v109
    v_exp_f32 v110, v110
    v_mfma_f32_16x16x32_bf16 v[152:155], v[232:235], v[216:219], v[152:155]
    v_exp_f32 v111, v111
    v_cvt_pk_bf16_f32 v108, v108, v109
    s_waitcnt lgkmcnt(1)
    v_mfma_f32_16x16x32_bf16 v[144:147], v[236:239], v[172:175], v[144:147]
    ds_read_b128 v[232:235], v251 offset:24576
    v_exp_f32 v112, v112
    v_exp_f32 v113, v113
    v_mfma_f32_16x16x32_bf16 v[148:151], v[236:239], v[196:199], v[148:151]
    v_cvt_pk_bf16_f32 v109, v110, v111
    v_exp_f32 v114, v114
    v_mfma_f32_16x16x32_bf16 v[152:155], v[236:239], v[220:223], v[152:155]
    v_exp_f32 v115, v115
    v_cvt_pk_bf16_f32 v112, v112, v113
    v_mfma_f32_16x16x32_bf16 v[144:147], v[240:243], v[176:179], v[144:147]
    ds_read_b128 v[236:239], v250 offset:24704
    v_exp_f32 v116, v116
    v_exp_f32 v117, v117
    v_mfma_f32_16x16x32_bf16 v[148:151], v[240:243], v[200:203], v[148:151]
    v_cvt_pk_bf16_f32 v113, v114, v115
    v_exp_f32 v118, v118
    v_mfma_f32_16x16x32_bf16 v[152:155], v[240:243], v[224:227], v[152:155]
    v_exp_f32 v119, v119
    v_cvt_pk_bf16_f32 v116, v116, v117
    v_cvt_pk_bf16_f32 v117, v118, v119
    s_waitcnt vmcnt(9)
    s_barrier
    s_waitcnt lgkmcnt(1)
    v_mfma_f32_16x16x32_bf16 v[120:123], v[228:231], v[156:159], 0
    ds_read_b128 v[240:243], v251 offset:24704
    v_mfma_f32_16x16x32_bf16 v[124:127], v[228:231], v[180:183], 0
    v_mfma_f32_16x16x32_bf16 v[128:131], v[228:231], v[204:207], 0
    s_add_u32 m0, s30, 98304
    s_add_u32 s31, s24, 73856
    buffer_load_dwordx4 v252, s[16:19], s31 offen offset:0 nt lds
    s_add_u32 s31, s24, 75904
    buffer_load_dwordx4 v252, s[16:19], s31 offen offset:1024 nt lds
    s_add_u32 s31, s24, 77952
    buffer_load_dwordx4 v252, s[16:19], s31 offen offset:2048 nt lds
    v_mfma_f32_16x16x32_bf16 v[120:123], v[232:235], v[160:163], v[120:123]
    ds_read_b128 v[228:231], v250 offset:24832
    v_mfma_f32_16x16x32_bf16 v[124:127], v[232:235], v[184:187], v[124:127]
    v_mfma_f32_16x16x32_bf16 v[128:131], v[232:235], v[208:211], v[128:131]
    s_waitcnt lgkmcnt(1)
    v_mfma_f32_16x16x32_bf16 v[120:123], v[236:239], v[164:167], v[120:123]
    ds_read_b128 v[232:235], v251 offset:24832
    v_fma_f32 v144, v144, s29, -v245
    v_fma_f32 v145, v145, s29, -v245
    v_fma_f32 v146, v146, s29, -v245
    v_fma_f32 v147, v147, s29, -v245
    v_mfma_f32_16x16x32_bf16 v[124:127], v[236:239], v[188:191], v[124:127]
    v_fma_f32 v148, v148, s29, -v247
    v_fma_f32 v149, v149, s29, -v247
    v_fma_f32 v150, v150, s29, -v247
    v_mfma_f32_16x16x32_bf16 v[128:131], v[236:239], v[212:215], v[128:131]
    v_fma_f32 v151, v151, s29, -v247
    v_fma_f32 v152, v152, s29, -v249
    v_fma_f32 v153, v153, s29, -v249
    v_fma_f32 v154, v154, s29, -v249
    v_mfma_f32_16x16x32_bf16 v[120:123], v[240:243], v[168:171], v[120:123]
    ds_read_b128 v[236:239], v250 offset:30720
    v_fma_f32 v155, v155, s29, -v249
    v_exp_f32 v144, v144
    v_mfma_f32_16x16x32_bf16 v[124:127], v[240:243], v[192:195], v[124:127]
    v_exp_f32 v145, v145
    v_exp_f32 v146, v146
    v_mfma_f32_16x16x32_bf16 v[128:131], v[240:243], v[216:219], v[128:131]
    v_exp_f32 v147, v147
    v_cvt_pk_bf16_f32 v110, v144, v145
    s_waitcnt lgkmcnt(1)
    v_mfma_f32_16x16x32_bf16 v[120:123], v[228:231], v[172:175], v[120:123]
    ds_read_b128 v[240:243], v251 offset:30720
    v_exp_f32 v148, v148
    v_exp_f32 v149, v149
    v_mfma_f32_16x16x32_bf16 v[124:127], v[228:231], v[196:199], v[124:127]
    v_cvt_pk_bf16_f32 v111, v146, v147
    v_exp_f32 v150, v150
    v_mfma_f32_16x16x32_bf16 v[128:131], v[228:231], v[220:223], v[128:131]
    v_exp_f32 v151, v151
    v_cvt_pk_bf16_f32 v114, v148, v149
    v_mfma_f32_16x16x32_bf16 v[120:123], v[232:235], v[176:179], v[120:123]
    ds_read_b128 v[228:231], v250 offset:30848
    v_exp_f32 v152, v152
    v_exp_f32 v153, v153
    v_mfma_f32_16x16x32_bf16 v[124:127], v[232:235], v[200:203], v[124:127]
    v_cvt_pk_bf16_f32 v115, v150, v151
    v_exp_f32 v154, v154
    v_mfma_f32_16x16x32_bf16 v[128:131], v[232:235], v[224:227], v[128:131]
    v_exp_f32 v155, v155
    v_cvt_pk_bf16_f32 v118, v152, v153
    v_cvt_pk_bf16_f32 v119, v154, v155
    s_waitcnt lgkmcnt(1)
    v_mfma_f32_16x16x32_bf16 v[144:147], v[236:239], v[156:159], 0
    ds_read_b128 v[232:235], v251 offset:30848
    v_mfma_f32_16x16x32_bf16 v[148:151], v[236:239], v[180:183], 0
    v_mfma_f32_16x16x32_bf16 v[152:155], v[236:239], v[204:207], 0
    v_mfma_f32_16x16x32_bf16 v[144:147], v[240:243], v[160:163], v[144:147]
    ds_read_b128 v[236:239], v250 offset:30976
    v_mfma_f32_16x16x32_bf16 v[148:151], v[240:243], v[184:187], v[148:151]
    v_mfma_f32_16x16x32_bf16 v[152:155], v[240:243], v[208:211], v[152:155]
    s_waitcnt lgkmcnt(1)
    v_mfma_f32_16x16x32_bf16 v[144:147], v[228:231], v[164:167], v[144:147]
    ds_read_b128 v[240:243], v251 offset:30976
    v_fma_f32 v120, v120, s29, -v245
    v_fma_f32 v121, v121, s29, -v245
    v_fma_f32 v122, v122, s29, -v245
    v_fma_f32 v123, v123, s29, -v245
    v_mfma_f32_16x16x32_bf16 v[148:151], v[228:231], v[188:191], v[148:151]
    v_fma_f32 v124, v124, s29, -v247
    v_fma_f32 v125, v125, s29, -v247
    v_fma_f32 v126, v126, s29, -v247
    v_mfma_f32_16x16x32_bf16 v[152:155], v[228:231], v[212:215], v[152:155]
    v_fma_f32 v127, v127, s29, -v247
    v_fma_f32 v128, v128, s29, -v249
    v_fma_f32 v129, v129, s29, -v249
    v_fma_f32 v130, v130, s29, -v249
    v_mfma_f32_16x16x32_bf16 v[144:147], v[232:235], v[168:171], v[144:147]
    ds_read_b128 v[228:231], v250 offset:36864
    v_fma_f32 v131, v131, s29, -v249
    v_exp_f32 v120, v120
    v_mfma_f32_16x16x32_bf16 v[148:151], v[232:235], v[192:195], v[148:151]
    v_exp_f32 v121, v121
    v_exp_f32 v122, v122
    v_mfma_f32_16x16x32_bf16 v[152:155], v[232:235], v[216:219], v[152:155]
    v_exp_f32 v123, v123
    v_cvt_pk_bf16_f32 v120, v120, v121
    s_waitcnt lgkmcnt(1)
    v_mfma_f32_16x16x32_bf16 v[144:147], v[236:239], v[172:175], v[144:147]
    ds_read_b128 v[232:235], v251 offset:36864
    v_exp_f32 v124, v124
    v_exp_f32 v125, v125
    v_mfma_f32_16x16x32_bf16 v[148:151], v[236:239], v[196:199], v[148:151]
    v_cvt_pk_bf16_f32 v121, v122, v123
    v_exp_f32 v126, v126
    v_mfma_f32_16x16x32_bf16 v[152:155], v[236:239], v[220:223], v[152:155]
    v_exp_f32 v127, v127
    v_cvt_pk_bf16_f32 v124, v124, v125
    v_mfma_f32_16x16x32_bf16 v[144:147], v[240:243], v[176:179], v[144:147]
    ds_read_b128 v[236:239], v250 offset:36992
    v_exp_f32 v128, v128
    v_exp_f32 v129, v129
    v_mfma_f32_16x16x32_bf16 v[148:151], v[240:243], v[200:203], v[148:151]
    v_cvt_pk_bf16_f32 v125, v126, v127
    v_exp_f32 v130, v130
    v_mfma_f32_16x16x32_bf16 v[152:155], v[240:243], v[224:227], v[152:155]
    v_exp_f32 v131, v131
    v_cvt_pk_bf16_f32 v128, v128, v129
    v_cvt_pk_bf16_f32 v129, v130, v131
    s_waitcnt lgkmcnt(1)
    v_mfma_f32_16x16x32_bf16 v[132:135], v[228:231], v[156:159], 0
    ds_read_b128 v[240:243], v251 offset:36992
    v_mfma_f32_16x16x32_bf16 v[136:139], v[228:231], v[180:183], 0
    v_mfma_f32_16x16x32_bf16 v[140:143], v[228:231], v[204:207], 0
    s_add_u32 m0, s30, 24576
    s_add_u32 s31, s24, 256
    buffer_load_dwordx4 v252, s[16:19], s31 offen offset:0 nt lds
    s_add_u32 s31, s24, 2304
    buffer_load_dwordx4 v252, s[16:19], s31 offen offset:1024 nt lds
    s_add_u32 s31, s24, 4352
    buffer_load_dwordx4 v252, s[16:19], s31 offen offset:2048 nt lds
    v_mfma_f32_16x16x32_bf16 v[132:135], v[232:235], v[160:163], v[132:135]
    ds_read_b128 v[228:231], v250 offset:37120
    v_mfma_f32_16x16x32_bf16 v[136:139], v[232:235], v[184:187], v[136:139]
    v_mfma_f32_16x16x32_bf16 v[140:143], v[232:235], v[208:211], v[140:143]
    s_waitcnt lgkmcnt(1)
    v_mfma_f32_16x16x32_bf16 v[132:135], v[236:239], v[164:167], v[132:135]
    ds_read_b128 v[232:235], v251 offset:37120
    v_fma_f32 v144, v144, s29, -v245
    v_fma_f32 v145, v145, s29, -v245
    v_fma_f32 v146, v146, s29, -v245
    v_fma_f32 v147, v147, s29, -v245
    v_mfma_f32_16x16x32_bf16 v[136:139], v[236:239], v[188:191], v[136:139]
    v_fma_f32 v148, v148, s29, -v247
    v_fma_f32 v149, v149, s29, -v247
    v_fma_f32 v150, v150, s29, -v247
    v_mfma_f32_16x16x32_bf16 v[140:143], v[236:239], v[212:215], v[140:143]
    v_fma_f32 v151, v151, s29, -v247
    v_fma_f32 v152, v152, s29, -v249
    v_fma_f32 v153, v153, s29, -v249
    v_fma_f32 v154, v154, s29, -v249
    v_mfma_f32_16x16x32_bf16 v[132:135], v[240:243], v[168:171], v[132:135]
    ds_read_b128 v[236:239], v250 offset:43008
    v_fma_f32 v155, v155, s29, -v249
    v_exp_f32 v144, v144
    v_mfma_f32_16x16x32_bf16 v[136:139], v[240:243], v[192:195], v[136:139]
    v_exp_f32 v145, v145
    v_exp_f32 v146, v146
    v_mfma_f32_16x16x32_bf16 v[140:143], v[240:243], v[216:219], v[140:143]
    v_exp_f32 v147, v147
    v_cvt_pk_bf16_f32 v122, v144, v145
    s_waitcnt lgkmcnt(1)
    v_mfma_f32_16x16x32_bf16 v[132:135], v[228:231], v[172:175], v[132:135]
    ds_read_b128 v[240:243], v251 offset:43008
    v_exp_f32 v148, v148
    v_exp_f32 v149, v149
    v_mfma_f32_16x16x32_bf16 v[136:139], v[228:231], v[196:199], v[136:139]
    v_cvt_pk_bf16_f32 v123, v146, v147
    v_exp_f32 v150, v150
    v_mfma_f32_16x16x32_bf16 v[140:143], v[228:231], v[220:223], v[140:143]
    v_exp_f32 v151, v151
    v_cvt_pk_bf16_f32 v126, v148, v149
    v_mfma_f32_16x16x32_bf16 v[132:135], v[232:235], v[176:179], v[132:135]
    ds_read_b128 v[228:231], v250 offset:43136
    v_exp_f32 v152, v152
    v_exp_f32 v153, v153
    v_mfma_f32_16x16x32_bf16 v[136:139], v[232:235], v[200:203], v[136:139]
    v_cvt_pk_bf16_f32 v127, v150, v151
    v_exp_f32 v154, v154
    v_mfma_f32_16x16x32_bf16 v[140:143], v[232:235], v[224:227], v[140:143]
    v_exp_f32 v155, v155
    v_cvt_pk_bf16_f32 v130, v152, v153
    v_cvt_pk_bf16_f32 v131, v154, v155
    s_waitcnt lgkmcnt(1)
    v_mfma_f32_16x16x32_bf16 v[144:147], v[236:239], v[156:159], 0
    ds_read_b128 v[232:235], v251 offset:43136
    v_mfma_f32_16x16x32_bf16 v[148:151], v[236:239], v[180:183], 0
    v_mfma_f32_16x16x32_bf16 v[152:155], v[236:239], v[204:207], 0
    v_mfma_f32_16x16x32_bf16 v[144:147], v[240:243], v[160:163], v[144:147]
    ds_read_b128 v[236:239], v250 offset:43264
    v_mfma_f32_16x16x32_bf16 v[148:151], v[240:243], v[184:187], v[148:151]
    v_mfma_f32_16x16x32_bf16 v[152:155], v[240:243], v[208:211], v[152:155]
    s_waitcnt lgkmcnt(1)
    v_mfma_f32_16x16x32_bf16 v[144:147], v[228:231], v[164:167], v[144:147]
    ds_read_b128 v[240:243], v251 offset:43264
    v_subrev_u32 v250, 0x18000, v250
    v_subrev_u32 v251, 0x18000, v251
    v_fma_f32 v132, v132, s29, -v245
    v_fma_f32 v133, v133, s29, -v245
    v_fma_f32 v134, v134, s29, -v245
    v_fma_f32 v135, v135, s29, -v245
    v_mfma_f32_16x16x32_bf16 v[148:151], v[228:231], v[188:191], v[148:151]
    v_fma_f32 v136, v136, s29, -v247
    v_fma_f32 v137, v137, s29, -v247
    v_fma_f32 v138, v138, s29, -v247
    v_mfma_f32_16x16x32_bf16 v[152:155], v[228:231], v[212:215], v[152:155]
    v_fma_f32 v139, v139, s29, -v247
    v_fma_f32 v140, v140, s29, -v249
    v_fma_f32 v141, v141, s29, -v249
    v_fma_f32 v142, v142, s29, -v249
    v_mfma_f32_16x16x32_bf16 v[144:147], v[232:235], v[168:171], v[144:147]
    v_fma_f32 v143, v143, s29, -v249
    v_exp_f32 v132, v132
    v_mfma_f32_16x16x32_bf16 v[148:151], v[232:235], v[192:195], v[148:151]
    v_exp_f32 v133, v133
    v_exp_f32 v134, v134
    v_mfma_f32_16x16x32_bf16 v[152:155], v[232:235], v[216:219], v[152:155]
    v_exp_f32 v135, v135
    v_cvt_pk_bf16_f32 v132, v132, v133
    s_waitcnt lgkmcnt(0)
    v_mfma_f32_16x16x32_bf16 v[144:147], v[236:239], v[172:175], v[144:147]
    v_exp_f32 v136, v136
    v_exp_f32 v137, v137
    v_mfma_f32_16x16x32_bf16 v[148:151], v[236:239], v[196:199], v[148:151]
    v_cvt_pk_bf16_f32 v133, v134, v135
    v_exp_f32 v138, v138
    v_mfma_f32_16x16x32_bf16 v[152:155], v[236:239], v[220:223], v[152:155]
    v_exp_f32 v139, v139
    v_cvt_pk_bf16_f32 v136, v136, v137
    v_mfma_f32_16x16x32_bf16 v[144:147], v[240:243], v[176:179], v[144:147]
    v_exp_f32 v140, v140
    v_exp_f32 v141, v141
    v_mfma_f32_16x16x32_bf16 v[148:151], v[240:243], v[200:203], v[148:151]
    v_cvt_pk_bf16_f32 v137, v138, v139
    v_exp_f32 v142, v142
    v_mfma_f32_16x16x32_bf16 v[152:155], v[240:243], v[224:227], v[152:155]
    v_exp_f32 v143, v143
    v_cvt_pk_bf16_f32 v140, v140, v141
    v_cvt_pk_bf16_f32 v141, v142, v143
    s_waitcnt vmcnt(9)
    s_barrier
L_p2:
    v_mbcnt_lo_u32_b32 v213, -1, 0
    v_mbcnt_hi_u32_b32 v213, -1, v213
    v_lshrrev_b32 v214, 2, v213
    v_bfe_u32 v215, v213, 3, 2
    v_lshlrev_b32 v215, 5, v215
    v_lshl_add_u32 v214, v214, 7, v215
    v_and_b32 v215, 3, v213
    v_lshl_add_u32 v204, v215, 3, v214
    v_xor_b32 v205, 32, v204
    v_xor_b32 v206, 64, v204
    v_xor_b32 v207, 96, v204
    ds_read_b64_tr_b16 v[228:229], v204 offset:0
    ds_read_b64_tr_b16 v[230:231], v204 offset:2048
    ds_read_b64_tr_b16 v[232:233], v205 offset:0
    ds_read_b64_tr_b16 v[234:235], v205 offset:2048
    ds_read_b64_tr_b16 v[236:237], v206 offset:0
    ds_read_b64_tr_b16 v[238:239], v206 offset:2048
    v_fma_f32 v144, v144, s29, -v245
    v_fma_f32 v145, v145, s29, -v245
    v_fma_f32 v146, v146, s29, -v245
    v_fma_f32 v147, v147, s29, -v245
    v_fma_f32 v148, v148, s29, -v247
    v_fma_f32 v149, v149, s29, -v247
    v_fma_f32 v150, v150, s29, -v247
    v_fma_f32 v151, v151, s29, -v247
    v_fma_f32 v152, v152, s29, -v249
    v_fma_f32 v153, v153, s29, -v249
    v_fma_f32 v154, v154, s29, -v249
    v_fma_f32 v155, v155, s29, -v249
    s_waitcnt lgkmcnt(2)
    v_mfma_f32_16x16x32_bf16 v[156:159], v[228:231], v[0:3], 0
    ds_read_b64_tr_b16 v[240:241], v207 offset:0
    ds_read_b64_tr_b16 v[242:243], v207 offset:2048
    v_exp_f32 v144, v144
    v_mfma_f32_16x16x32_bf16 v[172:175], v[228:231], v[4:7], 0
    v_exp_f32 v145, v145
    v_exp_f32 v146, v146
    v_mfma_f32_16x16x32_bf16 v[188:191], v[228:231], v[8:11], 0
    v_exp_f32 v147, v147
    v_cvt_pk_bf16_f32 v134, v144, v145
    s_add_u32 m0, s30, 122880
    s_add_u32 s31, s24, 73984
    buffer_load_dwordx4 v252, s[16:19], s31 offen offset:0 nt lds
    s_add_u32 s31, s24, 76032
    buffer_load_dwordx4 v252, s[16:19], s31 offen offset:1024 nt lds
    s_add_u32 s31, s24, 78080
    buffer_load_dwordx4 v252, s[16:19], s31 offen offset:2048 nt lds
    v_mfma_f32_16x16x32_bf16 v[160:163], v[232:235], v[0:3], 0
    ds_read_b64_tr_b16 v[228:229], v204 offset:4096
    ds_read_b64_tr_b16 v[230:231], v204 offset:6144
    v_exp_f32 v148, v148
    v_mfma_f32_16x16x32_bf16 v[176:179], v[232:235], v[4:7], 0
    v_exp_f32 v149, v149
    v_cvt_pk_bf16_f32 v135, v146, v147
    v_mfma_f32_16x16x32_bf16 v[192:195], v[232:235], v[8:11], 0
    v_exp_f32 v150, v150
    v_exp_f32 v151, v151
    s_waitcnt lgkmcnt(2)
    v_mfma_f32_16x16x32_bf16 v[164:167], v[236:239], v[0:3], 0
    ds_read_b64_tr_b16 v[232:233], v205 offset:4096
    ds_read_b64_tr_b16 v[234:235], v205 offset:6144
    v_cvt_pk_bf16_f32 v138, v148, v149
    v_mfma_f32_16x16x32_bf16 v[180:183], v[236:239], v[4:7], 0
    v_exp_f32 v152, v152
    v_exp_f32 v153, v153
    v_mfma_f32_16x16x32_bf16 v[196:199], v[236:239], v[8:11], 0
    v_cvt_pk_bf16_f32 v139, v150, v151
    v_exp_f32 v154, v154
    v_mfma_f32_16x16x32_bf16 v[168:171], v[240:243], v[0:3], 0
    ds_read_b64_tr_b16 v[236:237], v206 offset:4096
    ds_read_b64_tr_b16 v[238:239], v206 offset:6144
    v_exp_f32 v155, v155
    v_mfma_f32_16x16x32_bf16 v[184:187], v[240:243], v[4:7], 0
    v_cvt_pk_bf16_f32 v142, v152, v153
    v_cvt_pk_bf16_f32 v143, v154, v155
    v_mov_b32 v144, 0x3f803f80
    v_mfma_f32_16x16x32_bf16 v[200:203], v[240:243], v[8:11], 0
    v_mov_b32 v145, 0x3f803f80
    v_mov_b32 v146, 0x3f803f80
    v_mov_b32 v147, 0x3f803f80
    s_waitcnt lgkmcnt(2)
    v_mfma_f32_16x16x32_bf16 v[156:159], v[228:231], v[12:15], v[156:159]
    ds_read_b64_tr_b16 v[240:241], v207 offset:4096
    ds_read_b64_tr_b16 v[242:243], v207 offset:6144
    v_mfma_f32_16x16x32_bf16 v[216:219], v[144:147], v[0:3], 0
    v_mfma_f32_16x16x32_bf16 v[220:223], v[144:147], v[4:7], 0
    v_mfma_f32_16x16x32_bf16 v[224:227], v[144:147], v[8:11], 0
    v_add_u32 v214, 0, v213
    v_mfma_f32_16x16x32_bf16 v[172:175], v[228:231], v[16:19], v[172:175]
    v_mul_u32_u24 v214, 2731, v214
    v_mfma_f32_16x16x32_bf16 v[188:191], v[228:231], v[20:23], v[188:191]
    v_lshrrev_b32 v214, 17, v214
    v_mfma_f32_16x16x32_bf16 v[160:163], v[232:235], v[12:15], v[160:163]
    ds_read_b64_tr_b16 v[228:229], v204 offset:8192
    ds_read_b64_tr_b16 v[230:231], v204 offset:10240
    v_add_u32 v214, s32, v214
    v_mfma_f32_16x16x32_bf16 v[176:179], v[232:235], v[16:19], v[176:179]
    v_mfma_f32_16x16x32_bf16 v[216:219], v[144:147], v[12:15], v[216:219]
    v_mfma_f32_16x16x32_bf16 v[220:223], v[144:147], v[16:19], v[220:223]
    v_mfma_f32_16x16x32_bf16 v[224:227], v[144:147], v[20:23], v[224:227]
    v_and_b32 v214, 7, v214
    v_mfma_f32_16x16x32_bf16 v[192:195], v[232:235], v[20:23], v[192:195]
    v_xor_b32 v214, v214, v213
    v_lshl_add_u32 v208, v214, 4, s30
    s_waitcnt lgkmcnt(2)
    v_mfma_f32_16x16x32_bf16 v[164:167], v[236:239], v[12:15], v[164:167]
    ds_read_b64_tr_b16 v[232:233], v205 offset:8192
    ds_read_b64_tr_b16 v[234:235], v205 offset:10240
    v_add_u32 v214, 64, v213
    v_mfma_f32_16x16x32_bf16 v[180:183], v[236:239], v[16:19], v[180:183]
    v_mul_u32_u24 v214, 2731, v214
    v_mfma_f32_16x16x32_bf16 v[196:199], v[236:239], v[20:23], v[196:199]
    v_mfma_f32_16x16x32_bf16 v[216:219], v[144:147], v[24:27], v[216:219]
    v_mfma_f32_16x16x32_bf16 v[220:223], v[144:147], v[28:31], v[220:223]
    v_mfma_f32_16x16x32_bf16 v[224:227], v[144:147], v[32:35], v[224:227]
    v_lshrrev_b32 v214, 17, v214
    v_mfma_f32_16x16x32_bf16 v[168:171], v[240:243], v[12:15], v[168:171]
    ds_read_b64_tr_b16 v[236:237], v206 offset:8192
    ds_read_b64_tr_b16 v[238:239], v206 offset:10240
    v_add_u32 v214, s32, v214
    v_mfma_f32_16x16x32_bf16 v[184:187], v[240:243], v[16:19], v[184:187]
    v_and_b32 v214, 7, v214
    v_mfma_f32_16x16x32_bf16 v[200:203], v[240:243], v[20:23], v[200:203]
    v_xor_b32 v214, v214, v213
    s_waitcnt lgkmcnt(2)
    v_mfma_f32_16x16x32_bf16 v[156:159], v[228:231], v[24:27], v[156:159]
    ds_read_b64_tr_b16 v[240:241], v207 offset:8192
    ds_read_b64_tr_b16 v[242:243], v207 offset:10240
    v_mfma_f32_16x16x32_bf16 v[216:219], v[144:147], v[36:39], v[216:219]
    v_mfma_f32_16x16x32_bf16 v[220:223], v[144:147], v[40:43], v[220:223]
    v_mfma_f32_16x16x32_bf16 v[224:227], v[144:147], v[44:47], v[224:227]
    v_lshl_add_u32 v209, v214, 4, s30
    v_add_u32 v214, 128, v213
    v_mfma_f32_16x16x32_bf16 v[172:175], v[228:231], v[28:31], v[172:175]
    v_mul_u32_u24 v214, 2731, v214
    v_lshrrev_b32 v214, 17, v214
    v_mfma_f32_16x16x32_bf16 v[188:191], v[228:231], v[32:35], v[188:191]
    v_add_u32 v214, s32, v214
    v_mfma_f32_16x16x32_bf16 v[160:163], v[232:235], v[24:27], v[160:163]
    ds_read_b64_tr_b16 v[228:229], v204 offset:12288
    ds_read_b64_tr_b16 v[230:231], v204 offset:14336
    v_and_b32 v214, 7, v214
    v_xor_b32 v214, v214, v213
    v_mfma_f32_16x16x32_bf16 v[176:179], v[232:235], v[28:31], v[176:179]
    v_mfma_f32_16x16x32_bf16 v[216:219], v[144:147], v[48:51], v[216:219]
    v_mfma_f32_16x16x32_bf16 v[220:223], v[144:147], v[52:55], v[220:223]
    v_mfma_f32_16x16x32_bf16 v[224:227], v[144:147], v[56:59], v[224:227]
    v_lshl_add_u32 v210, v214, 4, s30
    v_and_b32 v214, 15, v213
    v_mfma_f32_16x16x32_bf16 v[192:195], v[232:235], v[32:35], v[192:195]
    v_mul_u32_u24 v214, 384, v214
    s_mul_i32 s34, s30, 6
    s_waitcnt lgkmcnt(2)
    v_mfma_f32_16x16x32_bf16 v[164:167], v[236:239], v[24:27], v[164:167]
    ds_read_b64_tr_b16 v[232:233], v205 offset:12288
    ds_read_b64_tr_b16 v[234:235], v205 offset:14336
    v_add_u32 v214, s34, v214
    v_mfma_f32_16x16x32_bf16 v[180:183], v[236:239], v[28:31], v[180:183]
    v_bfe_u32 v215, v213, 3, 1
    v_mul_u32_u24 v215, 3008, v215
    v_mfma_f32_16x16x32_bf16 v[196:199], v[236:239], v[32:35], v[196:199]
    v_mfma_f32_16x16x32_bf16 v[216:219], v[144:147], v[60:63], v[216:219]
    v_mfma_f32_16x16x32_bf16 v[220:223], v[144:147], v[64:67], v[220:223]
    v_mfma_f32_16x16x32_bf16 v[224:227], v[144:147], v[68:71], v[224:227]
    v_sub_u32 v214, v214, v215
    v_lshrrev_b32 v215, 4, v213
    v_mfma_f32_16x16x32_bf16 v[168:171], v[240:243], v[24:27], v[168:171]
    ds_read_b64_tr_b16 v[236:237], v206 offset:12288
    ds_read_b64_tr_b16 v[238:239], v206 offset:14336
    v_lshl_add_u32 v211, v215, 4, v214
    v_bfe_u32 v215, v213, 4, 1
    v_mfma_f32_16x16x32_bf16 v[184:187], v[240:243], v[28:31], v[184:187]
    v_lshl_add_u32 v214, v215, 5, v214
    v_mfma_f32_16x16x32_bf16 v[200:203], v[240:243], v[32:35], v[200:203]
    v_lshrrev_b32 v215, 5, v213
    v_lshl_add_u32 v212, v215, 4, v214
    s_waitcnt lgkmcnt(2)
    v_mfma_f32_16x16x32_bf16 v[156:159], v[228:231], v[36:39], v[156:159]
    ds_read_b64_tr_b16 v[240:241], v207 offset:12288
    ds_read_b64_tr_b16 v[242:243], v207 offset:14336
    v_mfma_f32_16x16x32_bf16 v[216:219], v[144:147], v[72:75], v[216:219]
    v_mfma_f32_16x16x32_bf16 v[220:223], v[144:147], v[76:79], v[220:223]
    v_mfma_f32_16x16x32_bf16 v[224:227], v[144:147], v[80:83], v[224:227]
    v_mfma_f32_16x16x32_bf16 v[172:175], v[228:231], v[40:43], v[172:175]
    v_mfma_f32_16x16x32_bf16 v[188:191], v[228:231], v[44:47], v[188:191]
    s_add_u32 s42, s25, 6272
    s_add_u32 m0, s43, 147456
    s_nop 0
    buffer_load_dwordx4 v211, s[8:11], s42 offen nt lds
    v_mfma_f32_16x16x32_bf16 v[160:163], v[232:235], v[36:39], v[160:163]
    ds_read_b64_tr_b16 v[228:229], v204 offset:16384
    ds_read_b64_tr_b16 v[230:231], v204 offset:18432
    v_mfma_f32_16x16x32_bf16 v[176:179], v[232:235], v[40:43], v[176:179]
    v_mfma_f32_16x16x32_bf16 v[216:219], v[144:147], v[84:87], v[216:219]
    v_mfma_f32_16x16x32_bf16 v[220:223], v[144:147], v[88:91], v[220:223]
    v_mfma_f32_16x16x32_bf16 v[224:227], v[144:147], v[92:95], v[224:227]
    v_mfma_f32_16x16x32_bf16 v[192:195], v[232:235], v[44:47], v[192:195]
    s_waitcnt lgkmcnt(2)
    v_mfma_f32_16x16x32_bf16 v[164:167], v[236:239], v[36:39], v[164:167]
    ds_read_b64_tr_b16 v[232:233], v205 offset:16384
    ds_read_b64_tr_b16 v[234:235], v205 offset:18432
    v_mfma_f32_16x16x32_bf16 v[180:183], v[236:239], v[40:43], v[180:183]
    v_mfma_f32_16x16x32_bf16 v[196:199], v[236:239], v[44:47], v[196:199]
    v_mfma_f32_16x16x32_bf16 v[216:219], v[144:147], v[96:99], v[216:219]
    v_mfma_f32_16x16x32_bf16 v[220:223], v[144:147], v[100:103], v[220:223]
    v_mfma_f32_16x16x32_bf16 v[224:227], v[144:147], v[104:107], v[224:227]
    v_mfma_f32_16x16x32_bf16 v[168:171], v[240:243], v[36:39], v[168:171]
    ds_read_b64_tr_b16 v[236:237], v206 offset:16384
    ds_read_b64_tr_b16 v[238:239], v206 offset:18432
    v_mfma_f32_16x16x32_bf16 v[184:187], v[240:243], v[40:43], v[184:187]
    v_mfma_f32_16x16x32_bf16 v[200:203], v[240:243], v[44:47], v[200:203]
    s_waitcnt lgkmcnt(2)
    v_mfma_f32_16x16x32_bf16 v[156:159], v[228:231], v[48:51], v[156:159]
    ds_read_b64_tr_b16 v[240:241], v207 offset:16384
    ds_read_b64_tr_b16 v[242:243], v207 offset:18432
    v_mfma_f32_16x16x32_bf16 v[216:219], v[144:147], v[108:111], v[216:219]
    v_mfma_f32_16x16x32_bf16 v[220:223], v[144:147], v[112:115], v[220:223]
    v_mfma_f32_16x16x32_bf16 v[224:227], v[144:147], v[116:119], v[224:227]
    v_mfma_f32_16x16x32_bf16 v[172:175], v[228:231], v[52:55], v[172:175]
    v_mfma_f32_16x16x32_bf16 v[188:191], v[228:231], v[56:59], v[188:191]
    s_add_u32 s42, s25, 9344
    s_add_u32 m0, s43, 148480
    s_nop 0
    buffer_load_dwordx4 v211, s[8:11], s42 offen nt lds
    v_mfma_f32_16x16x32_bf16 v[160:163], v[232:235], v[48:51], v[160:163]
    ds_read_b64_tr_b16 v[228:229], v204 offset:20480
    ds_read_b64_tr_b16 v[230:231], v204 offset:22528
    v_mfma_f32_16x16x32_bf16 v[176:179], v[232:235], v[52:55], v[176:179]
    v_mfma_f32_16x16x32_bf16 v[192:195], v[232:235], v[56:59], v[192:195]
    s_waitcnt lgkmcnt(2)
    v_mfma_f32_16x16x32_bf16 v[164:167], v[236:239], v[48:51], v[164:167]
    ds_read_b64_tr_b16 v[232:233], v205 offset:20480
    ds_read_b64_tr_b16 v[234:235], v205 offset:22528
    v_mfma_f32_16x16x32_bf16 v[216:219], v[144:147], v[120:123], v[216:219]
    v_mfma_f32_16x16x32_bf16 v[220:223], v[144:147], v[124:127], v[220:223]
    v_mfma_f32_16x16x32_bf16 v[224:227], v[144:147], v[128:131], v[224:227]
    v_mfma_f32_16x16x32_bf16 v[180:183], v[236:239], v[52:55], v[180:183]
    v_mfma_f32_16x16x32_bf16 v[196:199], v[236:239], v[56:59], v[196:199]
    v_mfma_f32_16x16x32_bf16 v[168:171], v[240:243], v[48:51], v[168:171]
    ds_read_b64_tr_b16 v[236:237], v206 offset:20480
    ds_read_b64_tr_b16 v[238:239], v206 offset:22528
    v_mfma_f32_16x16x32_bf16 v[184:187], v[240:243], v[52:55], v[184:187]
    v_mfma_f32_16x16x32_bf16 v[200:203], v[240:243], v[56:59], v[200:203]
    s_waitcnt lgkmcnt(2)
    v_mfma_f32_16x16x32_bf16 v[156:159], v[228:231], v[60:63], v[156:159]
    ds_read_b64_tr_b16 v[240:241], v207 offset:20480
    ds_read_b64_tr_b16 v[242:243], v207 offset:22528
    v_mfma_f32_16x16x32_bf16 v[216:219], v[144:147], v[132:135], v[216:219]
    v_mfma_f32_16x16x32_bf16 v[220:223], v[144:147], v[136:139], v[220:223]
    v_mfma_f32_16x16x32_bf16 v[224:227], v[144:147], v[140:143], v[224:227]
    v_mfma_f32_16x16x32_bf16 v[172:175], v[228:231], v[64:67], v[172:175]
    v_mfma_f32_16x16x32_bf16 v[188:191], v[228:231], v[68:71], v[188:191]
    v_mfma_f32_16x16x32_bf16 v[160:163], v[232:235], v[60:63], v[160:163]
    v_add_u32 v204, 0xc000, v204
    v_add_u32 v205, 0xc000, v205
    v_add_u32 v206, 0xc000, v206
    v_add_u32 v207, 0xc000, v207
    ds_read_b64_tr_b16 v[228:229], v204 offset:0
    ds_read_b64_tr_b16 v[230:231], v204 offset:2048
    v_mfma_f32_16x16x32_bf16 v[176:179], v[232:235], v[64:67], v[176:179]
    v_mfma_f32_16x16x32_bf16 v[192:195], v[232:235], v[68:71], v[192:195]
    s_waitcnt lgkmcnt(2)
    v_mfma_f32_16x16x32_bf16 v[164:167], v[236:239], v[60:63], v[164:167]
    ds_read_b64_tr_b16 v[232:233], v205 offset:0
    ds_read_b64_tr_b16 v[234:235], v205 offset:2048
    v_mfma_f32_16x16x32_bf16 v[180:183], v[236:239], v[64:67], v[180:183]
    v_mfma_f32_16x16x32_bf16 v[196:199], v[236:239], v[68:71], v[196:199]
    v_mfma_f32_16x16x32_bf16 v[168:171], v[240:243], v[60:63], v[168:171]
    ds_read_b64_tr_b16 v[236:237], v206 offset:0
    ds_read_b64_tr_b16 v[238:239], v206 offset:2048
    v_add_f32 v253, v216, v220
    v_add_f32 v253, v253, v224
    v_cmp_ngt_f32 vcc, s48, v253
    s_andn2_b64 s[46:47], vcc, s[44:45]
    s_cbranch_scc1 L_slow
    v_mfma_f32_16x16x32_bf16 v[184:187], v[240:243], v[64:67], v[184:187]
    v_mfma_f32_16x16x32_bf16 v[200:203], v[240:243], v[68:71], v[200:203]
    s_waitcnt vmcnt(11)
    s_barrier
    s_waitcnt lgkmcnt(2)
    v_mfma_f32_16x16x32_bf16 v[156:159], v[228:231], v[72:75], v[156:159]
    ds_read_b64_tr_b16 v[240:241], v207 offset:0
    ds_read_b64_tr_b16 v[242:243], v207 offset:2048
    v_mfma_f32_16x16x32_bf16 v[172:175], v[228:231], v[76:79], v[172:175]
    v_mfma_f32_16x16x32_bf16 v[188:191], v[228:231], v[80:83], v[188:191]
    s_add_u32 m0, s30, 0
    s_add_u32 s31, s25, 0
    buffer_load_dwordx4 v208, s[12:15], s31 offen offset:0 nt lds
    buffer_load_dwordx4 v209, s[12:15], s31 offen offset:1024 nt lds
    buffer_load_dwordx4 v210, s[12:15], s31 offen offset:2048 nt lds
    v_mfma_f32_16x16x32_bf16 v[160:163], v[232:235], v[72:75], v[160:163]
    ds_read_b64_tr_b16 v[228:229], v204 offset:4096
    ds_read_b64_tr_b16 v[230:231], v204 offset:6144
    v_mfma_f32_16x16x32_bf16 v[176:179], v[232:235], v[76:79], v[176:179]
    v_mfma_f32_16x16x32_bf16 v[192:195], v[232:235], v[80:83], v[192:195]
    s_waitcnt lgkmcnt(2)
    v_mfma_f32_16x16x32_bf16 v[164:167], v[236:239], v[72:75], v[164:167]
    ds_read_b64_tr_b16 v[232:233], v205 offset:4096
    ds_read_b64_tr_b16 v[234:235], v205 offset:6144
    v_mfma_f32_16x16x32_bf16 v[180:183], v[236:239], v[76:79], v[180:183]
    v_mfma_f32_16x16x32_bf16 v[196:199], v[236:239], v[80:83], v[196:199]
    v_mfma_f32_16x16x32_bf16 v[168:171], v[240:243], v[72:75], v[168:171]
    ds_read_b64_tr_b16 v[236:237], v206 offset:4096
    ds_read_b64_tr_b16 v[238:239], v206 offset:6144
    v_mfma_f32_16x16x32_bf16 v[184:187], v[240:243], v[76:79], v[184:187]
    v_mfma_f32_16x16x32_bf16 v[200:203], v[240:243], v[80:83], v[200:203]
    s_waitcnt lgkmcnt(2)
    v_mfma_f32_16x16x32_bf16 v[156:159], v[228:231], v[84:87], v[156:159]
    ds_read_b64_tr_b16 v[240:241], v207 offset:4096
    ds_read_b64_tr_b16 v[242:243], v207 offset:6144
    v_mfma_f32_16x16x32_bf16 v[172:175], v[228:231], v[88:91], v[172:175]
    v_mfma_f32_16x16x32_bf16 v[188:191], v[228:231], v[92:95], v[188:191]
    v_rcp_f32 v244, v216
    v_rcp_f32 v246, v220
    v_rcp_f32 v248, v224
    v_mfma_f32_16x16x32_bf16 v[160:163], v[232:235], v[84:87], v[160:163]
    ds_read_b64_tr_b16 v[228:229], v204 offset:8192
    ds_read_b64_tr_b16 v[230:231], v204 offset:10240
    v_mfma_f32_16x16x32_bf16 v[176:179], v[232:235], v[88:91], v[176:179]
    v_mfma_f32_16x16x32_bf16 v[192:195], v[232:235], v[92:95], v[192:195]
    s_waitcnt lgkmcnt(2)
    v_mfma_f32_16x16x32_bf16 v[164:167], v[236:239], v[84:87], v[164:167]
    ds_read_b64_tr_b16 v[232:233], v205 offset:8192
    ds_read_b64_tr_b16 v[234:235], v205 offset:10240
    v_mfma_f32_16x16x32_bf16 v[180:183], v[236:239], v[88:91], v[180:183]
    v_mfma_f32_16x16x32_bf16 v[196:199], v[236:239], v[92:95], v[196:199]
    v_mfma_f32_16x16x32_bf16 v[168:171], v[240:243], v[84:87], v[168:171]
    ds_read_b64_tr_b16 v[236:237], v206 offset:8192
    ds_read_b64_tr_b16 v[238:239], v206 offset:10240
    v_mfma_f32_16x16x32_bf16 v[184:187], v[240:243], v[88:91], v[184:187]
    v_mfma_f32_16x16x32_bf16 v[200:203], v[240:243], v[92:95], v[200:203]
    s_waitcnt lgkmcnt(2)
    v_mfma_f32_16x16x32_bf16 v[156:159], v[228:231], v[96:99], v[156:159]
    ds_read_b64_tr_b16 v[240:241], v207 offset:8192
    ds_read_b64_tr_b16 v[242:243], v207 offset:10240
    v_mfma_f32_16x16x32_bf16 v[172:175], v[228:231], v[100:103], v[172:175]
    v_mfma_f32_16x16x32_bf16 v[188:191], v[228:231], v[104:107], v[188:191]
    v_mfma_f32_16x16x32_bf16 v[160:163], v[232:235], v[96:99], v[160:163]
    ds_read_b64_tr_b16 v[228:229], v204 offset:12288
    ds_read_b64_tr_b16 v[230:231], v204 offset:14336
    v_mfma_f32_16x16x32_bf16 v[176:179], v[232:235], v[100:103], v[176:179]
    v_mfma_f32_16x16x32_bf16 v[192:195], v[232:235], v[104:107], v[192:195]
    s_waitcnt lgkmcnt(2)
    v_mfma_f32_16x16x32_bf16 v[164:167], v[236:239], v[96:99], v[164:167]
    ds_read_b64_tr_b16 v[232:233], v205 offset:12288
    ds_read_b64_tr_b16 v[234:235], v205 offset:14336
    v_mfma_f32_16x16x32_bf16 v[180:183], v[236:239], v[100:103], v[180:183]
    v_mfma_f32_16x16x32_bf16 v[196:199], v[236:239], v[104:107], v[196:199]
    v_mfma_f32_16x16x32_bf16 v[168:171], v[240:243], v[96:99], v[168:171]
    ds_read_b64_tr_b16 v[236:237], v206 offset:12288
    ds_read_b64_tr_b16 v[238:239], v206 offset:14336
    v_mfma_f32_16x16x32_bf16 v[184:187], v[240:243], v[100:103], v[184:187]
    v_mfma_f32_16x16x32_bf16 v[200:203], v[240:243], v[104:107], v[200:203]
    s_waitcnt lgkmcnt(2)
    v_mfma_f32_16x16x32_bf16 v[156:159], v[228:231], v[108:111], v[156:159]
    ds_read_b64_tr_b16 v[240:241], v207 offset:12288
    ds_read_b64_tr_b16 v[242:243], v207 offset:14336
    v_mfma_f32_16x16x32_bf16 v[172:175], v[228:231], v[112:115], v[172:175]
    v_mfma_f32_16x16x32_bf16 v[188:191], v[228:231], v[116:119], v[188:191]
    v_mfma_f32_16x16x32_bf16 v[160:163], v[232:235], v[108:111], v[160:163]
    ds_read_b64_tr_b16 v[228:229], v204 offset:16384
    ds_read_b64_tr_b16 v[230:231], v204 offset:18432
    v_mfma_f32_16x16x32_bf16 v[176:179], v[232:235], v[112:115], v[176:179]
    v_mfma_f32_16x16x32_bf16 v[192:195], v[232:235], v[116:119], v[192:195]
    s_waitcnt lgkmcnt(2)
    v_mfma_f32_16x16x32_bf16 v[164:167], v[236:239], v[108:111], v[164:167]
    ds_read_b64_tr_b16 v[232:233], v205 offset:16384
    ds_read_b64_tr_b16 v[234:235], v205 offset:18432
    v_mfma_f32_16x16x32_bf16 v[180:183], v[236:239], v[112:115], v[180:183]
    v_mfma_f32_16x16x32_bf16 v[196:199], v[236:239], v[116:119], v[196:199]
    v_mfma_f32_16x16x32_bf16 v[168:171], v[240:243], v[108:111], v[168:171]
    ds_read_b64_tr_b16 v[236:237], v206 offset:16384
    ds_read_b64_tr_b16 v[238:239], v206 offset:18432
    v_mfma_f32_16x16x32_bf16 v[184:187], v[240:243], v[112:115], v[184:187]
    v_mfma_f32_16x16x32_bf16 v[200:203], v[240:243], v[116:119], v[200:203]
    s_waitcnt lgkmcnt(2)
    v_mfma_f32_16x16x32_bf16 v[156:159], v[228:231], v[120:123], v[156:159]
    ds_read_b64_tr_b16 v[240:241], v207 offset:16384
    ds_read_b64_tr_b16 v[242:243], v207 offset:18432
    v_mfma_f32_16x16x32_bf16 v[172:175], v[228:231], v[124:127], v[172:175]
    v_mfma_f32_16x16x32_bf16 v[188:191], v[228:231], v[128:131], v[188:191]
    v_mfma_f32_16x16x32_bf16 v[160:163], v[232:235], v[120:123], v[160:163]
    ds_read_b64_tr_b16 v[228:229], v204 offset:20480
    ds_read_b64_tr_b16 v[230:231], v204 offset:22528
    v_mfma_f32_16x16x32_bf16 v[176:179], v[232:235], v[124:127], v[176:179]
    v_mfma_f32_16x16x32_bf16 v[192:195], v[232:235], v[128:131], v[192:195]
    s_waitcnt lgkmcnt(2)
    v_mfma_f32_16x16x32_bf16 v[164:167], v[236:239], v[120:123], v[164:167]
    ds_read_b64_tr_b16 v[232:233], v205 offset:20480
    ds_read_b64_tr_b16 v[234:235], v205 offset:22528
    v_mfma_f32_16x16x32_bf16 v[180:183], v[236:239], v[124:127], v[180:183]
    v_mfma_f32_16x16x32_bf16 v[196:199], v[236:239], v[128:131], v[196:199]
    v_mfma_f32_16x16x32_bf16 v[168:171], v[240:243], v[120:123], v[168:171]
    ds_read_b64_tr_b16 v[236:237], v206 offset:20480
    ds_read_b64_tr_b16 v[238:239], v206 offset:22528
    v_mfma_f32_16x16x32_bf16 v[184:187], v[240:243], v[124:127], v[184:187]
    v_mfma_f32_16x16x32_bf16 v[200:203], v[240:243], v[128:131], v[200:203]
    s_waitcnt lgkmcnt(2)
    v_mfma_f32_16x16x32_bf16 v[156:159], v[228:231], v[132:135], v[156:159]
    ds_read_b64_tr_b16 v[240:241], v207 offset:20480
    ds_read_b64_tr_b16 v[242:243], v207 offset:22528
    v_mfma_f32_16x16x32_bf16 v[172:175], v[228:231], v[136:139], v[172:175]
    v_mfma_f32_16x16x32_bf16 v[188:191], v[228:231], v[140:143], v[188:191]
    v_mfma_f32_16x16x32_bf16 v[160:163], v[232:235], v[132:135], v[160:163]
    ds_read_b64_tr_b16 v[228:229], v204 offset:24576
    ds_read_b64_tr_b16 v[230:231], v204 offset:26624
    v_mfma_f32_16x16x32_bf16 v[176:179], v[232:235], v[136:139], v[176:179]
    v_mfma_f32_16x16x32_bf16 v[192:195], v[232:235], v[140:143], v[192:195]
    s_waitcnt lgkmcnt(2)
    v_mfma_f32_16x16x32_bf16 v[164:167], v[236:239], v[132:135], v[164:167]
    ds_read_b64_tr_b16 v[232:233], v205 offset:24576
    ds_read_b64_tr_b16 v[234:235], v205 offset:26624
    v_mul_f32 v156, v156, v244
    v_mul_f32 v157, v157, v244
    v_mul_f32 v158, v158, v244
    v_mul_f32 v159, v159, v244
    v_cvt_pk_bf16_f32 v216, v156, v157
    v_mfma_f32_16x16x32_bf16 v[180:183], v[236:239], v[136:139], v[180:183]
    v_cvt_pk_bf16_f32 v217, v158, v159
    v_mul_f32 v172, v172, v246
    v_mul_f32 v173, v173, v246
    v_mul_f32 v174, v174, v246
    v_mfma_f32_16x16x32_bf16 v[196:199], v[236:239], v[140:143], v[196:199]
    v_mul_f32 v175, v175, v246
    v_cvt_pk_bf16_f32 v224, v172, v173
    v_cvt_pk_bf16_f32 v225, v174, v175
    v_mul_f32 v188, v188, v248
    v_mul_f32 v189, v189, v248
    v_mfma_f32_16x16x32_bf16 v[168:171], v[240:243], v[132:135], v[168:171]
    ds_read_b64_tr_b16 v[236:237], v206 offset:24576
    ds_read_b64_tr_b16 v[238:239], v206 offset:26624
    v_mul_f32 v190, v190, v248
    v_mul_f32 v191, v191, v248
    v_cvt_pk_bf16_f32 v148, v188, v189
    v_cvt_pk_bf16_f32 v149, v190, v191
    v_mfma_f32_16x16x32_bf16 v[184:187], v[240:243], v[136:139], v[184:187]
    v_mul_f32 v160, v160, v244
    v_mul_f32 v161, v161, v244
    v_mul_f32 v162, v162, v244
    v_mul_f32 v163, v163, v244
    v_cvt_pk_bf16_f32 v218, v160, v161
    v_mfma_f32_16x16x32_bf16 v[200:203], v[240:243], v[140:143], v[200:203]
    v_cvt_pk_bf16_f32 v219, v162, v163
    v_mul_f32 v176, v176, v246
    v_mul_f32 v177, v177, v246
    v_mul_f32 v178, v178, v246
    s_waitcnt vmcnt(11)
    s_barrier
    s_waitcnt lgkmcnt(2)
    v_mfma_f32_16x16x32_bf16 v[156:159], v[228:231], v[0:3], 0
    ds_read_b64_tr_b16 v[240:241], v207 offset:24576
    ds_read_b64_tr_b16 v[242:243], v207 offset:26624
    v_mul_f32 v179, v179, v246
    v_cvt_pk_bf16_f32 v226, v176, v177
    v_cvt_pk_bf16_f32 v227, v178, v179
    v_mul_f32 v192, v192, v248
    v_mul_f32 v193, v193, v248
    v_mfma_f32_16x16x32_bf16 v[172:175], v[228:231], v[4:7], 0
    v_mul_f32 v194, v194, v248
    v_mul_f32 v195, v195, v248
    v_cvt_pk_bf16_f32 v150, v192, v193
    v_cvt_pk_bf16_f32 v151, v194, v195
    v_mfma_f32_16x16x32_bf16 v[188:191], v[228:231], v[8:11], 0
    v_mul_f32 v164, v164, v244
    v_mul_f32 v165, v165, v244
    v_mul_f32 v166, v166, v244
    v_mul_f32 v167, v167, v244
    v_cvt_pk_bf16_f32 v220, v164, v165
    s_add_u32 s42, s25, 0
    s_add_u32 m0, s30, 49152
    s_nop 0
    buffer_load_dwordx4 v211, s[8:11], s42 offen nt lds
    v_mfma_f32_16x16x32_bf16 v[160:163], v[232:235], v[0:3], 0
    ds_read_b64_tr_b16 v[228:229], v204 offset:28672
    ds_read_b64_tr_b16 v[230:231], v204 offset:30720
    v_cvt_pk_bf16_f32 v221, v166, v167
    v_mul_f32 v180, v180, v246
    v_mul_f32 v181, v181, v246
    v_mul_f32 v182, v182, v246
    v_mfma_f32_16x16x32_bf16 v[176:179], v[232:235], v[4:7], 0
    v_mul_f32 v183, v183, v246
    v_cvt_pk_bf16_f32 v144, v180, v181
    v_cvt_pk_bf16_f32 v145, v182, v183
    v_mul_f32 v196, v196, v248
    v_mul_f32 v197, v197, v248
    v_mfma_f32_16x16x32_bf16 v[192:195], v[232:235], v[8:11], 0
    v_mul_f32 v198, v198, v248
    v_mul_f32 v199, v199, v248
    v_cvt_pk_bf16_f32 v152, v196, v197
    v_cvt_pk_bf16_f32 v153, v198, v199
    s_waitcnt lgkmcnt(2)
    v_mfma_f32_16x16x32_bf16 v[164:167], v[236:239], v[0:3], 0
    ds_read_b64_tr_b16 v[232:233], v205 offset:28672
    ds_read_b64_tr_b16 v[234:235], v205 offset:30720
    v_mul_f32 v168, v168, v244
    v_mul_f32 v169, v169, v244
    v_mul_f32 v170, v170, v244
    v_mul_f32 v171, v171, v244
    v_cvt_pk_bf16_f32 v222, v168, v169
    v_mfma_f32_16x16x32_bf16 v[180:183], v[236:239], v[4:7], 0
    v_cvt_pk_bf16_f32 v223, v170, v171
    v_mul_f32 v184, v184, v246
    v_mul_f32 v185, v185, v246
    v_mul_f32 v186, v186, v246
    v_mfma_f32_16x16x32_bf16 v[196:199], v[236:239], v[8:11], 0
    v_mul_f32 v187, v187, v246
    v_cvt_pk_bf16_f32 v146, v184, v185
    v_cvt_pk_bf16_f32 v147, v186, v187
    v_mul_f32 v200, v200, v248
    v_mul_f32 v201, v201, v248
    v_mfma_f32_16x16x32_bf16 v[168:171], v[240:243], v[0:3], 0
    ds_read_b64_tr_b16 v[236:237], v206 offset:28672
    ds_read_b64_tr_b16 v[238:239], v206 offset:30720
    v_mul_f32 v202, v202, v248
    v_mul_f32 v203, v203, v248
    v_cvt_pk_bf16_f32 v154, v200, v201
    v_cvt_pk_bf16_f32 v155, v202, v203
    v_mfma_f32_16x16x32_bf16 v[184:187], v[240:243], v[4:7], 0
    v_mfma_f32_16x16x32_bf16 v[200:203], v[240:243], v[8:11], 0
    v_permlane16_swap_b32 v216, v218
    v_permlane16_swap_b32 v217, v219
    v_permlane16_swap_b32 v220, v222
    v_permlane16_swap_b32 v221, v223
    s_waitcnt lgkmcnt(2)
    v_mfma_f32_16x16x32_bf16 v[156:159], v[228:231], v[12:15], v[156:159]
    ds_read_b64_tr_b16 v[240:241], v207 offset:28672
    ds_read_b64_tr_b16 v[242:243], v207 offset:30720
    v_mov_b32 v253, v216
    v_mfma_f32_16x16x32_bf16 v[172:175], v[228:231], v[16:19], v[172:175]
    v_mov_b32 v254, v217
    v_mfma_f32_16x16x32_bf16 v[188:191], v[228:231], v[20:23], v[188:191]
    v_mov_b32_dpp v216, v220 row_ror:8 row_mask:0xf bank_mask:0xc
    s_add_u32 s42, s25, 128
    s_add_u32 m0, s30, 50176
    s_nop 0
    buffer_load_dwordx4 v211, s[8:11], s42 offen nt lds
    v_mfma_f32_16x16x32_bf16 v[160:163], v[232:235], v[12:15], v[160:163]
    ds_read_b64_tr_b16 v[228:229], v204 offset:32768
    ds_read_b64_tr_b16 v[230:231], v204 offset:34816
    v_mov_b32_dpp v217, v221 row_ror:8 row_mask:0xf bank_mask:0xc
    v_mfma_f32_16x16x32_bf16 v[176:179], v[232:235], v[16:19], v[176:179]
    v_mov_b32_dpp v220, v253 row_ror:8 row_mask:0xf bank_mask:0x3
    v_mfma_f32_16x16x32_bf16 v[192:195], v[232:235], v[20:23], v[192:195]
    v_mov_b32_dpp v221, v254 row_ror:8 row_mask:0xf bank_mask:0x3
    s_waitcnt lgkmcnt(2)
    v_mfma_f32_16x16x32_bf16 v[164:167], v[236:239], v[12:15], v[164:167]
    ds_read_b64_tr_b16 v[232:233], v205 offset:32768
    ds_read_b64_tr_b16 v[234:235], v205 offset:34816
    v_mov_b32 v253, v218
    v_mfma_f32_16x16x32_bf16 v[180:183], v[236:239], v[16:19], v[180:183]
    v_mov_b32 v254, v219
    v_mfma_f32_16x16x32_bf16 v[196:199], v[236:239], v[20:23], v[196:199]
    v_mov_b32_dpp v218, v222 row_ror:8 row_mask:0xf bank_mask:0xc
    v_mfma_f32_16x16x32_bf16 v[168:171], v[240:243], v[12:15], v[168:171]
    ds_read_b64_tr_b16 v[236:237], v206 offset:32768
    ds_read_b64_tr_b16 v[238:239], v206 offset:34816
    v_mov_b32_dpp v219, v223 row_ror:8 row_mask:0xf bank_mask:0xc
    v_mfma_f32_16x16x32_bf16 v[184:187], v[240:243], v[16:19], v[184:187]
    v_mov_b32_dpp v222, v253 row_ror:8 row_mask:0xf bank_mask:0x3
    v_mfma_f32_16x16x32_bf16 v[200:203], v[240:243], v[20:23], v[200:203]
    v_mov_b32_dpp v223, v254 row_ror:8 row_mask:0xf bank_mask:0x3
    s_waitcnt lgkmcnt(2)
    v_mfma_f32_16x16x32_bf16 v[156:159], v[228:231], v[24:27], v[156:159]
    ds_read_b64_tr_b16 v[240:241], v207 offset:32768
    ds_read_b64_tr_b16 v[242:243], v207 offset:34816
    v_permlane16_swap_b32 v224, v226
    v_mfma_f32_16x16x32_bf16 v[172:175], v[228:231], v[28:31], v[172:175]
    v_mfma_f32_16x16x32_bf16 v[188:191], v[228:231], v[32:35], v[188:191]
    v_permlane16_swap_b32 v225, v227
    s_add_u32 s34, s26, 0
    buffer_store_dwordx4 v[216:219], v212, s[20:23], s34 offen offset:0
    v_mfma_f32_16x16x32_bf16 v[160:163], v[232:235], v[24:27], v[160:163]
    ds_read_b64_tr_b16 v[228:229], v204 offset:36864
    ds_read_b64_tr_b16 v[230:231], v204 offset:38912
    v_permlane16_swap_b32 v144, v146
    v_mfma_f32_16x16x32_bf16 v[176:179], v[232:235], v[28:31], v[176:179]
    v_mfma_f32_16x16x32_bf16 v[192:195], v[232:235], v[32:35], v[192:195]
    v_permlane16_swap_b32 v145, v147
    s_waitcnt lgkmcnt(2)
    v_mfma_f32_16x16x32_bf16 v[164:167], v[236:239], v[24:27], v[164:167]
    ds_read_b64_tr_b16 v[232:233], v205 offset:36864
    ds_read_b64_tr_b16 v[234:235], v205 offset:38912
    v_mov_b32 v253, v224
    v_mfma_f32_16x16x32_bf16 v[180:183], v[236:239], v[28:31], v[180:183]
    v_mfma_f32_16x16x32_bf16 v[196:199], v[236:239], v[32:35], v[196:199]
    v_mov_b32 v254, v225
    v_mfma_f32_16x16x32_bf16 v[168:171], v[240:243], v[24:27], v[168:171]
    ds_read_b64_tr_b16 v[236:237], v206 offset:36864
    ds_read_b64_tr_b16 v[238:239], v206 offset:38912
    v_mov_b32_dpp v224, v144 row_ror:8 row_mask:0xf bank_mask:0xc
    v_mfma_f32_16x16x32_bf16 v[184:187], v[240:243], v[28:31], v[184:187]
    v_mfma_f32_16x16x32_bf16 v[200:203], v[240:243], v[32:35], v[200:203]
    v_mov_b32_dpp v225, v145 row_ror:8 row_mask:0xf bank_mask:0xc
    s_waitcnt lgkmcnt(2)
    v_mfma_f32_16x16x32_bf16 v[156:159], v[228:231], v[36:39], v[156:159]
    ds_read_b64_tr_b16 v[240:241], v207 offset:36864
    ds_read_b64_tr_b16 v[242:243], v207 offset:38912
    v_mov_b32_dpp v144, v253 row_ror:8 row_mask:0xf bank_mask:0x3
    v_mfma_f32_16x16x32_bf16 v[172:175], v[228:231], v[40:43], v[172:175]
    v_mfma_f32_16x16x32_bf16 v[188:191], v[228:231], v[44:47], v[188:191]
    v_mov_b32_dpp v145, v254 row_ror:8 row_mask:0xf bank_mask:0x3
    s_add_u32 s34, s26, 0
    buffer_store_dwordx4 v[220:223], v212, s[20:23], s34 offen offset:3072
    v_mfma_f32_16x16x32_bf16 v[160:163], v[232:235], v[36:39], v[160:163]
    ds_read_b64_tr_b16 v[228:229], v204 offset:40960
    ds_read_b64_tr_b16 v[230:231], v204 offset:43008
    v_mov_b32 v253, v226
    v_mfma_f32_16x16x32_bf16 v[176:179], v[232:235], v[40:43], v[176:179]
    v_mfma_f32_16x16x32_bf16 v[192:195], v[232:235], v[44:47], v[192:195]
    v_mov_b32 v254, v227
    s_waitcnt lgkmcnt(2)
    v_mfma_f32_16x16x32_bf16 v[164:167], v[236:239], v[36:39], v[164:167]
    ds_read_b64_tr_b16 v[232:233], v205 offset:40960
    ds_read_b64_tr_b16 v[234:235], v205 offset:43008
    v_mov_b32_dpp v226, v146 row_ror:8 row_mask:0xf bank_mask:0xc
    v_mfma_f32_16x16x32_bf16 v[180:183], v[236:239], v[40:43], v[180:183]
    v_mfma_f32_16x16x32_bf16 v[196:199], v[236:239], v[44:47], v[196:199]
    v_mov_b32_dpp v227, v147 row_ror:8 row_mask:0xf bank_mask:0xc
    v_mfma_f32_16x16x32_bf16 v[168:171], v[240:243], v[36:39], v[168:171]
    ds_read_b64_tr_b16 v[236:237], v206 offset:40960
    ds_read_b64_tr_b16 v[238:239], v206 offset:43008
    v_mov_b32_dpp v146, v253 row_ror:8 row_mask:0xf bank_mask:0x3
    v_mfma_f32_16x16x32_bf16 v[184:187], v[240:243], v[40:43], v[184:187]
    v_mfma_f32_16x16x32_bf16 v[200:203], v[240:243], v[44:47], v[200:203]
    v_mov_b32_dpp v147, v254 row_ror:8 row_mask:0xf bank_mask:0x3
    s_waitcnt lgkmcnt(2)
    v_mfma_f32_16x16x32_bf16 v[156:159], v[228:231], v[48:51], v[156:159]
    ds_read_b64_tr_b16 v[240:241], v207 offset:40960
    ds_read_b64_tr_b16 v[242:243], v207 offset:43008
    v_permlane16_swap_b32 v148, v150
    v_mfma_f32_16x16x32_bf16 v[172:175], v[228:231], v[52:55], v[172:175]
    v_mfma_f32_16x16x32_bf16 v[188:191], v[228:231], v[56:59], v[188:191]
    v_permlane16_swap_b32 v149, v151
    s_add_u32 s34, s26, 6144
    buffer_store_dwordx4 v[224:227], v212, s[20:23], s34 offen offset:0
    v_mfma_f32_16x16x32_bf16 v[160:163], v[232:235], v[48:51], v[160:163]
    ds_read_b64_tr_b16 v[228:229], v204 offset:45056
    ds_read_b64_tr_b16 v[230:231], v204 offset:47104
    v_permlane16_swap_b32 v152, v154
    v_mfma_f32_16x16x32_bf16 v[176:179], v[232:235], v[52:55], v[176:179]
    v_mfma_f32_16x16x32_bf16 v[192:195], v[232:235], v[56:59], v[192:195]
    v_permlane16_swap_b32 v153, v155
    s_waitcnt lgkmcnt(2)
    v_mfma_f32_16x16x32_bf16 v[164:167], v[236:239], v[48:51], v[164:167]
    ds_read_b64_tr_b16 v[232:233], v205 offset:45056
    ds_read_b64_tr_b16 v[234:235], v205 offset:47104
    v_mov_b32 v253, v148
    v_mfma_f32_16x16x32_bf16 v[180:183], v[236:239], v[52:55], v[180:183]
    v_mfma_f32_16x16x32_bf16 v[196:199], v[236:239], v[56:59], v[196:199]
    v_mov_b32 v254, v149
    v_mfma_f32_16x16x32_bf16 v[168:171], v[240:243], v[48:51], v[168:171]
    ds_read_b64_tr_b16 v[236:237], v206 offset:45056
    ds_read_b64_tr_b16 v[238:239], v206 offset:47104
    v_mov_b32_dpp v148, v152 row_ror:8 row_mask:0xf bank_mask:0xc
    v_mfma_f32_16x16x32_bf16 v[184:187], v[240:243], v[52:55], v[184:187]
    v_mfma_f32_16x16x32_bf16 v[200:203], v[240:243], v[56:59], v[200:203]
    v_mov_b32_dpp v149, v153 row_ror:8 row_mask:0xf bank_mask:0xc
    s_waitcnt lgkmcnt(2)
    v_mfma_f32_16x16x32_bf16 v[156:159], v[228:231], v[60:63], v[156:159]
    ds_read_b64_tr_b16 v[240:241], v207 offset:45056
    ds_read_b64_tr_b16 v[242:243], v207 offset:47104
    v_mov_b32_dpp v152, v253 row_ror:8 row_mask:0xf bank_mask:0x3
    v_mfma_f32_16x16x32_bf16 v[172:175], v[228:231], v[64:67], v[172:175]
    v_mfma_f32_16x16x32_bf16 v[188:191], v[228:231], v[68:71], v[188:191]
    v_mov_b32_dpp v153, v254 row_ror:8 row_mask:0xf bank_mask:0x3
    s_add_u32 s42, s25, 256
    s_add_u32 m0, s30, 51200
    s_nop 0
    buffer_load_dwordx4 v211, s[8:11], s42 offen nt lds
    v_mfma_f32_16x16x32_bf16 v[160:163], v[232:235], v[60:63], v[160:163]
    v_add_u32 v204, 0xc000, v204
    v_add_u32 v205, 0xc000, v205
    v_add_u32 v206, 0xc000, v206
    v_add_u32 v207, 0xc000, v207
    ds_read_b64_tr_b16 v[228:229], v204 offset:0
    ds_read_b64_tr_b16 v[230:231], v204 offset:2048
    v_mov_b32 v253, v150
    v_mfma_f32_16x16x32_bf16 v[176:179], v[232:235], v[64:67], v[176:179]
    v_mfma_f32_16x16x32_bf16 v[192:195], v[232:235], v[68:71], v[192:195]
    v_mov_b32 v254, v151
    s_waitcnt lgkmcnt(2)
    v_mfma_f32_16x16x32_bf16 v[164:167], v[236:239], v[60:63], v[164:167]
    ds_read_b64_tr_b16 v[232:233], v205 offset:0
    ds_read_b64_tr_b16 v[234:235], v205 offset:2048
    v_mov_b32_dpp v150, v154 row_ror:8 row_mask:0xf bank_mask:0xc
    v_mfma_f32_16x16x32_bf16 v[180:183], v[236:239], v[64:67], v[180:183]
    v_mfma_f32_16x16x32_bf16 v[196:199], v[236:239], v[68:71], v[196:199]
    v_mov_b32_dpp v151, v155 row_ror:8 row_mask:0xf bank_mask:0xc
    v_mfma_f32_16x16x32_bf16 v[168:171], v[240:243], v[60:63], v[168:171]
    ds_read_b64_tr_b16 v[236:237], v206 offset:0
    ds_read_b64_tr_b16 v[238:239], v206 offset:2048
    v_mov_b32_dpp v154, v253 row_ror:8 row_mask:0xf bank_mask:0x3
    v_mfma_f32_16x16x32_bf16 v[184:187], v[240:243], v[64:67], v[184:187]
    v_mfma_f32_16x16x32_bf16 v[200:203], v[240:243], v[68:71], v[200:203]
    v_mov_b32_dpp v155, v254 row_ror:8 row_mask:0xf bank_mask:0x3
    s_waitcnt vmcnt(14)
    s_barrier
    s_waitcnt lgkmcnt(2)
    v_mfma_f32_16x16x32_bf16 v[156:159], v[228:231], v[72:75], v[156:159]
    ds_read_b64_tr_b16 v[240:241], v207 offset:0
    ds_read_b64_tr_b16 v[242:243], v207 offset:2048
    v_mfma_f32_16x16x32_bf16 v[172:175], v[228:231], v[76:79], v[172:175]
    v_mfma_f32_16x16x32_bf16 v[188:191], v[228:231], v[80:83], v[188:191]
    s_add_u32 s42, s25, 3072
    s_add_u32 m0, s30, 73728
    s_nop 0
    buffer_load_dwordx4 v211, s[8:11], s42 offen nt lds
    v_mfma_f32_16x16x32_bf16 v[160:163], v[232:235], v[72:75], v[160:163]
    ds_read_b64_tr_b16 v[228:229], v204 offset:4096
    ds_read_b64_tr_b16 v[230:231], v204 offset:6144
    v_mfma_f32_16x16x32_bf16 v[176:179], v[232:235], v[76:79], v[176:179]
    v_mfma_f32_16x16x32_bf16 v[192:195], v[232:235], v[80:83], v[192:195]
    s_waitcnt lgkmcnt(2)
    v_mfma_f32_16x16x32_bf16 v[164:167], v[236:239], v[72:75], v[164:167]
    ds_read_b64_tr_b16 v[232:233], v205 offset:4096
    ds_read_b64_tr_b16 v[234:235], v205 offset:6144
    v_mfma_f32_16x16x32_bf16 v[180:183], v[236:239], v[76:79], v[180:183]
    v_mfma_f32_16x16x32_bf16 v[196:199], v[236:239], v[80:83], v[196:199]
    v_mfma_f32_16x16x32_bf16 v[168:171], v[240:243], v[72:75], v[168:171]
    ds_read_b64_tr_b16 v[236:237], v206 offset:4096
    ds_read_b64_tr_b16 v[238:239], v206 offset:6144
    v_mfma_f32_16x16x32_bf16 v[184:187], v[240:243], v[76:79], v[184:187]
    v_mfma_f32_16x16x32_bf16 v[200:203], v[240:243], v[80:83], v[200:203]
    s_waitcnt lgkmcnt(2)
    v_mfma_f32_16x16x32_bf16 v[156:159], v[228:231], v[84:87], v[156:159]
    ds_read_b64_tr_b16 v[240:241], v207 offset:4096
    ds_read_b64_tr_b16 v[242:243], v207 offset:6144
    v_mfma_f32_16x16x32_bf16 v[172:175], v[228:231], v[88:91], v[172:175]
    v_mfma_f32_16x16x32_bf16 v[188:191], v[228:231], v[92:95], v[188:191]
    s_add_u32 s42, s25, 3200
    s_add_u32 m0, s30, 74752
    s_nop 0
    buffer_load_dwordx4 v211, s[8:11], s42 offen nt lds
    v_mfma_f32_16x16x32_bf16 v[160:163], v[232:235], v[84:87], v[160:163]
    ds_read_b64_tr_b16 v[228:229], v204 offset:8192
    ds_read_b64_tr_b16 v[230:231], v204 offset:10240
    v_mfma_f32_16x16x32_bf16 v[176:179], v[232:235], v[88:91], v[176:179]
    v_mfma_f32_16x16x32_bf16 v[192:195], v[232:235], v[92:95], v[192:195]
    s_waitcnt lgkmcnt(2)
    v_mfma_f32_16x16x32_bf16 v[164:167], v[236:239], v[84:87], v[164:167]
    ds_read_b64_tr_b16 v[232:233], v205 offset:8192
    ds_read_b64_tr_b16 v[234:235], v205 offset:10240
    v_mfma_f32_16x16x32_bf16 v[180:183], v[236:239], v[88:91], v[180:183]
    v_mfma_f32_16x16x32_bf16 v[196:199], v[236:239], v[92:95], v[196:199]
    v_mfma_f32_16x16x32_bf16 v[168:171], v[240:243], v[84:87], v[168:171]
    ds_read_b64_tr_b16 v[236:237], v206 offset:8192
    ds_read_b64_tr_b16 v[238:239], v206 offset:10240
    v_mfma_f32_16x16x32_bf16 v[184:187], v[240:243], v[88:91], v[184:187]
    v_mfma_f32_16x16x32_bf16 v[200:203], v[240:243], v[92:95], v[200:203]
    s_waitcnt lgkmcnt(2)
    v_mfma_f32_16x16x32_bf16 v[156:159], v[228:231], v[96:99], v[156:159]
    ds_read_b64_tr_b16 v[240:241], v207 offset:8192
    ds_read_b64_tr_b16 v[242:243], v207 offset:10240
    v_mfma_f32_16x16x32_bf16 v[172:175], v[228:231], v[100:103], v[172:175]
    v_mfma_f32_16x16x32_bf16 v[188:191], v[228:231], v[104:107], v[188:191]
    s_add_u32 s42, s25, 3328
    s_add_u32 m0, s30, 75776
    s_nop 0
    buffer_load_dwordx4 v211, s[8:11], s42 offen nt lds
    v_mfma_f32_16x16x32_bf16 v[160:163], v[232:235], v[96:99], v[160:163]
    ds_read_b64_tr_b16 v[228:229], v204 offset:12288
    ds_read_b64_tr_b16 v[230:231], v204 offset:14336
    v_mfma_f32_16x16x32_bf16 v[176:179], v[232:235], v[100:103], v[176:179]
    v_mfma_f32_16x16x32_bf16 v[192:195], v[232:235], v[104:107], v[192:195]
    s_waitcnt lgkmcnt(2)
    v_mfma_f32_16x16x32_bf16 v[164:167], v[236:239], v[96:99], v[164:167]
    ds_read_b64_tr_b16 v[232:233], v205 offset:12288
    ds_read_b64_tr_b16 v[234:235], v205 offset:14336
    v_mfma_f32_16x16x32_bf16 v[180:183], v[236:239], v[100:103], v[180:183]
    v_mfma_f32_16x16x32_bf16 v[196:199], v[236:239], v[104:107], v[196:199]
    v_mfma_f32_16x16x32_bf16 v[168:171], v[240:243], v[96:99], v[168:171]
    ds_read_b64_tr_b16 v[236:237], v206 offset:12288
    ds_read_b64_tr_b16 v[238:239], v206 offset:14336
    v_mfma_f32_16x16x32_bf16 v[184:187], v[240:243], v[100:103], v[184:187]
    v_mfma_f32_16x16x32_bf16 v[200:203], v[240:243], v[104:107], v[200:203]
    s_waitcnt lgkmcnt(2)
    v_mfma_f32_16x16x32_bf16 v[156:159], v[228:231], v[108:111], v[156:159]
    ds_read_b64_tr_b16 v[240:241], v207 offset:12288
    ds_read_b64_tr_b16 v[242:243], v207 offset:14336
    v_mfma_f32_16x16x32_bf16 v[172:175], v[228:231], v[112:115], v[172:175]
    v_mfma_f32_16x16x32_bf16 v[188:191], v[228:231], v[116:119], v[188:191]
    s_add_u32 s34, s26, 6144
    buffer_store_dwordx4 v[144:147], v212, s[20:23], s34 offen offset:3072
    v_mfma_f32_16x16x32_bf16 v[160:163], v[232:235], v[108:111], v[160:163]
    ds_read_b64_tr_b16 v[228:229], v204 offset:16384
    ds_read_b64_tr_b16 v[230:231], v204 offset:18432
    v_mfma_f32_16x16x32_bf16 v[176:179], v[232:235], v[112:115], v[176:179]
    v_mfma_f32_16x16x32_bf16 v[192:195], v[232:235], v[116:119], v[192:195]
    s_waitcnt lgkmcnt(2)
    v_mfma_f32_16x16x32_bf16 v[164:167], v[236:239], v[108:111], v[164:167]
    ds_read_b64_tr_b16 v[232:233], v205 offset:16384
    ds_read_b64_tr_b16 v[234:235], v205 offset:18432
    v_mfma_f32_16x16x32_bf16 v[180:183], v[236:239], v[112:115], v[180:183]
    v_mfma_f32_16x16x32_bf16 v[196:199], v[236:239], v[116:119], v[196:199]
    v_mfma_f32_16x16x32_bf16 v[168:171], v[240:243], v[108:111], v[168:171]
    ds_read_b64_tr_b16 v[236:237], v206 offset:16384
    ds_read_b64_tr_b16 v[238:239], v206 offset:18432
    v_mfma_f32_16x16x32_bf16 v[184:187], v[240:243], v[112:115], v[184:187]
    v_mfma_f32_16x16x32_bf16 v[200:203], v[240:243], v[116:119], v[200:203]
    s_waitcnt lgkmcnt(2)
    v_mfma_f32_16x16x32_bf16 v[156:159], v[228:231], v[120:123], v[156:159]
    ds_read_b64_tr_b16 v[240:241], v207 offset:16384
    ds_read_b64_tr_b16 v[242:243], v207 offset:18432
    v_mfma_f32_16x16x32_bf16 v[172:175], v[228:231], v[124:127], v[172:175]
    v_mfma_f32_16x16x32_bf16 v[188:191], v[228:231], v[128:131], v[188:191]
    s_add_u32 s34, s26, 12288
    buffer_store_dwordx4 v[148:151], v212, s[20:23], s34 offen offset:0
    v_mfma_f32_16x16x32_bf16 v[160:163], v[232:235], v[120:123], v[160:163]
    ds_read_b64_tr_b16 v[228:229], v204 offset:20480
    ds_read_b64_tr_b16 v[230:231], v204 offset:22528
    v_mfma_f32_16x16x32_bf16 v[176:179], v[232:235], v[124:127], v[176:179]
    v_mfma_f32_16x16x32_bf16 v[192:195], v[232:235], v[128:131], v[192:195]
    s_waitcnt lgkmcnt(2)
    v_mfma_f32_16x16x32_bf16 v[164:167], v[236:239], v[120:123], v[164:167]
    ds_read_b64_tr_b16 v[232:233], v205 offset:20480
    ds_read_b64_tr_b16 v[234:235], v205 offset:22528
    v_mfma_f32_16x16x32_bf16 v[180:183], v[236:239], v[124:127], v[180:183]
    v_mfma_f32_16x16x32_bf16 v[196:199], v[236:239], v[128:131], v[196:199]
    v_mfma_f32_16x16x32_bf16 v[168:171], v[240:243], v[120:123], v[168:171]
    ds_read_b64_tr_b16 v[236:237], v206 offset:20480
    ds_read_b64_tr_b16 v[238:239], v206 offset:22528
    v_mfma_f32_16x16x32_bf16 v[184:187], v[240:243], v[124:127], v[184:187]
    v_mfma_f32_16x16x32_bf16 v[200:203], v[240:243], v[128:131], v[200:203]
    s_waitcnt lgkmcnt(2)
    v_mfma_f32_16x16x32_bf16 v[156:159], v[228:231], v[132:135], v[156:159]
    ds_read_b64_tr_b16 v[240:241], v207 offset:20480
    ds_read_b64_tr_b16 v[242:243], v207 offset:22528
    v_mfma_f32_16x16x32_bf16 v[172:175], v[228:231], v[136:139], v[172:175]
    v_mfma_f32_16x16x32_bf16 v[188:191], v[228:231], v[140:143], v[188:191]
    s_add_u32 s34, s26, 12288
    buffer_store_dwordx4 v[152:155], v212, s[20:23], s34 offen offset:3072
    v_mfma_f32_16x16x32_bf16 v[160:163], v[232:235], v[132:135], v[160:163]
    v_subrev_u32 v204, 0x18000, v204
    v_subrev_u32 v205, 0x18000, v205
    v_subrev_u32 v206, 0x18000, v206
    v_subrev_u32 v207, 0x18000, v207
    ds_read_b64_tr_b16 v[228:229], v204 offset:24576
    ds_read_b64_tr_b16 v[230:231], v204 offset:26624
    v_mfma_f32_16x16x32_bf16 v[176:179], v[232:235], v[136:139], v[176:179]
    v_mfma_f32_16x16x32_bf16 v[192:195], v[232:235], v[140:143], v[192:195]
    s_waitcnt lgkmcnt(2)
    v_mfma_f32_16x16x32_bf16 v[164:167], v[236:239], v[132:135], v[164:167]
    ds_read_b64_tr_b16 v[232:233], v205 offset:24576
    ds_read_b64_tr_b16 v[234:235], v205 offset:26624
    v_mul_f32 v156, v156, v244
    v_mul_f32 v157, v157, v244
    v_mul_f32 v158, v158, v244
    v_mul_f32 v159, v159, v244
    v_cvt_pk_bf16_f32 v216, v156, v157
    v_mfma_f32_16x16x32_bf16 v[180:183], v[236:239], v[136:139], v[180:183]
    v_cvt_pk_bf16_f32 v217, v158, v159
    v_mul_f32 v172, v172, v246
    v_mul_f32 v173, v173, v246
    v_mul_f32 v174, v174, v246
    v_mfma_f32_16x16x32_bf16 v[196:199], v[236:239], v[140:143], v[196:199]
    v_mul_f32 v175, v175, v246
    v_cvt_pk_bf16_f32 v224, v172, v173
    v_cvt_pk_bf16_f32 v225, v174, v175
    v_mul_f32 v188, v188, v248
    v_mul_f32 v189, v189, v248
    v_mfma_f32_16x16x32_bf16 v[168:171], v[240:243], v[132:135], v[168:171]
    ds_read_b64_tr_b16 v[236:237], v206 offset:24576
    ds_read_b64_tr_b16 v[238:239], v206 offset:26624
    v_mul_f32 v190, v190, v248
    v_mul_f32 v191, v191, v248
    v_cvt_pk_bf16_f32 v148, v188, v189
    v_cvt_pk_bf16_f32 v149, v190, v191
    v_mfma_f32_16x16x32_bf16 v[184:187], v[240:243], v[136:139], v[184:187]
    v_mul_f32 v160, v160, v244
    v_mul_f32 v161, v161, v244
    v_mul_f32 v162, v162, v244
    v_mul_f32 v163, v163, v244
    v_cvt_pk_bf16_f32 v218, v160, v161
    v_mfma_f32_16x16x32_bf16 v[200:203], v[240:243], v[140:143], v[200:203]
    v_cvt_pk_bf16_f32 v219, v162, v163
    v_mul_f32 v176, v176, v246
    v_mul_f32 v177, v177, v246
    v_mul_f32 v178, v178, v246
    s_waitcnt vmcnt(17)
    s_barrier
    s_waitcnt lgkmcnt(2)
    v_mfma_f32_16x16x32_bf16 v[156:159], v[228:231], v[0:3], 0
    ds_read_b64_tr_b16 v[240:241], v207 offset:24576
    ds_read_b64_tr_b16 v[242:243], v207 offset:26624
    v_mul_f32 v179, v179, v246
    v_cvt_pk_bf16_f32 v226, v176, v177
    v_cvt_pk_bf16_f32 v227, v178, v179
    v_mul_f32 v192, v192, v248
    v_mul_f32 v193, v193, v248
    v_mfma_f32_16x16x32_bf16 v[172:175], v[228:231], v[4:7], 0
    v_mul_f32 v194, v194, v248
    v_mul_f32 v195, v195, v248
    v_cvt_pk_bf16_f32 v150, v192, v193
    v_cvt_pk_bf16_f32 v151, v194, v195
    v_mfma_f32_16x16x32_bf16 v[188:191], v[228:231], v[8:11], 0
    v_mul_f32 v164, v164, v244
    v_mul_f32 v165, v165, v244
    v_mul_f32 v166, v166, v244
    v_mul_f32 v167, v167, v244
    v_cvt_pk_bf16_f32 v220, v164, v165
    s_add_u32 s42, s25, 6144
    s_add_u32 m0, s30, 98304
    s_nop 0
    buffer_load_dwordx4 v211, s[8:11], s42 offen nt lds
    v_mfma_f32_16x16x32_bf16 v[160:163], v[232:235], v[0:3], 0
    ds_read_b64_tr_b16 v[228:229], v204 offset:28672
    ds_read_b64_tr_b16 v[230:231], v204 offset:30720
    v_cvt_pk_bf16_f32 v221, v166, v167
    v_mul_f32 v180, v180, v246
    v_mul_f32 v181, v181, v246
    v_mul_f32 v182, v182, v246
    v_mfma_f32_16x16x32_bf16 v[176:179], v[232:235], v[4:7], 0
    v_mul_f32 v183, v183, v246
    v_cvt_pk_bf16_f32 v144, v180, v181
    v_cvt_pk_bf16_f32 v145, v182, v183
    v_mul_f32 v196, v196, v248
    v_mul_f32 v197, v197, v248
    v_mfma_f32_16x16x32_bf16 v[192:195], v[232:235], v[8:11], 0
    v_mul_f32 v198, v198, v248
    v_mul_f32 v199, v199, v248
    v_cvt_pk_bf16_f32 v152, v196, v197
    v_cvt_pk_bf16_f32 v153, v198, v199
    s_waitcnt lgkmcnt(2)
    v_mfma_f32_16x16x32_bf16 v[164:167], v[236:239], v[0:3], 0
    ds_read_b64_tr_b16 v[232:233], v205 offset:28672
    ds_read_b64_tr_b16 v[234:235], v205 offset:30720
    v_mul_f32 v168, v168, v244
    v_mul_f32 v169, v169, v244
    v_mul_f32 v170, v170, v244
    v_mul_f32 v171, v171, v244
    v_cvt_pk_bf16_f32 v222, v168, v169
    v_mfma_f32_16x16x32_bf16 v[180:183], v[236:239], v[4:7], 0
    v_cvt_pk_bf16_f32 v223, v170, v171
    v_mul_f32 v184, v184, v246
    v_mul_f32 v185, v185, v246
    v_mul_f32 v186, v186, v246
    v_mfma_f32_16x16x32_bf16 v[196:199], v[236:239], v[8:11], 0
    v_mul_f32 v187, v187, v246
    v_cvt_pk_bf16_f32 v146, v184, v185
    v_cvt_pk_bf16_f32 v147, v186, v187
    v_mul_f32 v200, v200, v248
    v_mul_f32 v201, v201, v248
    s_add_u32 s42, s25, 9216
    s_add_u32 m0, s30, 99328
    s_nop 0
    buffer_load_dwordx4 v211, s[8:11], s42 offen nt lds
    v_mfma_f32_16x16x32_bf16 v[168:171], v[240:243], v[0:3], 0
    ds_read_b64_tr_b16 v[236:237], v206 offset:28672
    ds_read_b64_tr_b16 v[238:239], v206 offset:30720
    v_mul_f32 v202, v202, v248
    v_mul_f32 v203, v203, v248
    v_cvt_pk_bf16_f32 v154, v200, v201
    v_cvt_pk_bf16_f32 v155, v202, v203
    v_mfma_f32_16x16x32_bf16 v[184:187], v[240:243], v[4:7], 0
    v_mfma_f32_16x16x32_bf16 v[200:203], v[240:243], v[8:11], 0
    v_permlane16_swap_b32 v216, v218
    v_permlane16_swap_b32 v217, v219
    v_permlane16_swap_b32 v220, v222
    v_permlane16_swap_b32 v221, v223
    s_waitcnt lgkmcnt(2)
    v_mfma_f32_16x16x32_bf16 v[156:159], v[228:231], v[12:15], v[156:159]
    ds_read_b64_tr_b16 v[240:241], v207 offset:28672
    ds_read_b64_tr_b16 v[242:243], v207 offset:30720
    v_mov_b32 v253, v216
    v_mfma_f32_16x16x32_bf16 v[172:175], v[228:231], v[16:19], v[172:175]
    v_mov_b32 v254, v217
    v_mfma_f32_16x16x32_bf16 v[188:191], v[228:231], v[20:23], v[188:191]
    v_mov_b32_dpp v216, v220 row_ror:8 row_mask:0xf bank_mask:0xc
    s_add_u32 s42, s25, 6400
    buffer_load_dwordx4 v[0:3], v211, s[8:11], s42 offen nt
    v_mfma_f32_16x16x32_bf16 v[160:163], v[232:235], v[12:15], v[160:163]
    ds_read_b64_tr_b16 v[228:229], v204 offset:32768
    ds_read_b64_tr_b16 v[230:231], v204 offset:34816
    v_mov_b32_dpp v217, v221 row_ror:8 row_mask:0xf bank_mask:0xc
    v_mfma_f32_16x16x32_bf16 v[176:179], v[232:235], v[16:19], v[176:179]
    v_mov_b32_dpp v220, v253 row_ror:8 row_mask:0xf bank_mask:0x3
    v_mfma_f32_16x16x32_bf16 v[192:195], v[232:235], v[20:23], v[192:195]
    v_mov_b32_dpp v221, v254 row_ror:8 row_mask:0xf bank_mask:0x3
    s_waitcnt lgkmcnt(2)
    v_mfma_f32_16x16x32_bf16 v[164:167], v[236:239], v[12:15], v[164:167]
    ds_read_b64_tr_b16 v[232:233], v205 offset:32768
    ds_read_b64_tr_b16 v[234:235], v205 offset:34816
    v_mov_b32 v253, v218
    v_mfma_f32_16x16x32_bf16 v[180:183], v[236:239], v[16:19], v[180:183]
    v_mov_b32 v254, v219
    v_mfma_f32_16x16x32_bf16 v[196:199], v[236:239], v[20:23], v[196:199]
    v_mov_b32_dpp v218, v222 row_ror:8 row_mask:0xf bank_mask:0xc
    v_mfma_f32_16x16x32_bf16 v[168:171], v[240:243], v[12:15], v[168:171]
    ds_read_b64_tr_b16 v[236:237], v206 offset:32768
    ds_read_b64_tr_b16 v[238:239], v206 offset:34816
    v_mov_b32_dpp v219, v223 row_ror:8 row_mask:0xf bank_mask:0xc
    v_mfma_f32_16x16x32_bf16 v[184:187], v[240:243], v[16:19], v[184:187]
    v_mov_b32_dpp v222, v253 row_ror:8 row_mask:0xf bank_mask:0x3
    v_mfma_f32_16x16x32_bf16 v[200:203], v[240:243], v[20:23], v[200:203]
    v_mov_b32_dpp v223, v254 row_ror:8 row_mask:0xf bank_mask:0x3
    s_waitcnt lgkmcnt(2)
    v_mfma_f32_16x16x32_bf16 v[156:159], v[228:231], v[24:27], v[156:159]
    ds_read_b64_tr_b16 v[240:241], v207 offset:32768
    ds_read_b64_tr_b16 v[242:243], v207 offset:34816
    v_permlane16_swap_b32 v224, v226
    v_mfma_f32_16x16x32_bf16 v[172:175], v[228:231], v[28:31], v[172:175]
    v_mfma_f32_16x16x32_bf16 v[188:191], v[228:231], v[32:35], v[188:191]
    v_permlane16_swap_b32 v225, v227
    s_add_u32 s42, s25, 9472
    buffer_load_dwordx4 v[4:7], v211, s[8:11], s42 offen nt
    v_mfma_f32_16x16x32_bf16 v[160:163], v[232:235], v[24:27], v[160:163]
    ds_read_b64_tr_b16 v[228:229], v204 offset:36864
    ds_read_b64_tr_b16 v[230:231], v204 offset:38912
    v_permlane16_swap_b32 v144, v146
    v_mfma_f32_16x16x32_bf16 v[176:179], v[232:235], v[28:31], v[176:179]
    v_mfma_f32_16x16x32_bf16 v[192:195], v[232:235], v[32:35], v[192:195]
    v_permlane16_swap_b32 v145, v147
    s_waitcnt lgkmcnt(2)
    v_mfma_f32_16x16x32_bf16 v[164:167], v[236:239], v[24:27], v[164:167]
    ds_read_b64_tr_b16 v[232:233], v205 offset:36864
    ds_read_b64_tr_b16 v[234:235], v205 offset:38912
    v_mov_b32 v253, v224
    v_mfma_f32_16x16x32_bf16 v[180:183], v[236:239], v[28:31], v[180:183]
    v_mfma_f32_16x16x32_bf16 v[196:199], v[236:239], v[32:35], v[196:199]
    v_mov_b32 v254, v225
    s_add_u32 s42, s25, 12288
    buffer_load_dwordx4 v[8:11], v211, s[8:11], s42 offen nt
    v_mfma_f32_16x16x32_bf16 v[168:171], v[240:243], v[24:27], v[168:171]
    ds_read_b64_tr_b16 v[236:237], v206 offset:36864
    ds_read_b64_tr_b16 v[238:239], v206 offset:38912
    v_mov_b32_dpp v224, v144 row_ror:8 row_mask:0xf bank_mask:0xc
    v_mfma_f32_16x16x32_bf16 v[184:187], v[240:243], v[28:31], v[184:187]
    v_mfma_f32_16x16x32_bf16 v[200:203], v[240:243], v[32:35], v[200:203]
    v_mov_b32_dpp v225, v145 row_ror:8 row_mask:0xf bank_mask:0xc
    s_waitcnt lgkmcnt(2)
    v_mfma_f32_16x16x32_bf16 v[156:159], v[228:231], v[36:39], v[156:159]
    ds_read_b64_tr_b16 v[240:241], v207 offset:36864
    ds_read_b64_tr_b16 v[242:243], v207 offset:38912
    v_mov_b32_dpp v144, v253 row_ror:8 row_mask:0xf bank_mask:0x3
    v_mfma_f32_16x16x32_bf16 v[172:175], v[228:231], v[40:43], v[172:175]
    v_mfma_f32_16x16x32_bf16 v[188:191], v[228:231], v[44:47], v[188:191]
    v_mov_b32_dpp v145, v254 row_ror:8 row_mask:0xf bank_mask:0x3
    s_add_u32 s42, s25, 15360
    buffer_load_dwordx4 v[12:15], v211, s[8:11], s42 offen nt
    v_mfma_f32_16x16x32_bf16 v[160:163], v[232:235], v[36:39], v[160:163]
    ds_read_b64_tr_b16 v[228:229], v204 offset:40960
    ds_read_b64_tr_b16 v[230:231], v204 offset:43008
    v_mov_b32 v253, v226
    v_mfma_f32_16x16x32_bf16 v[176:179], v[232:235], v[40:43], v[176:179]
    v_mfma_f32_16x16x32_bf16 v[192:195], v[232:235], v[44:47], v[192:195]
    v_mov_b32 v254, v227
    s_waitcnt lgkmcnt(2)
    v_mfma_f32_16x16x32_bf16 v[164:167], v[236:239], v[36:39], v[164:167]
    ds_read_b64_tr_b16 v[232:233], v205 offset:40960
    ds_read_b64_tr_b16 v[234:235], v205 offset:43008
    v_mov_b32_dpp v226, v146 row_ror:8 row_mask:0xf bank_mask:0xc
    v_mfma_f32_16x16x32_bf16 v[180:183], v[236:239], v[40:43], v[180:183]
    v_mfma_f32_16x16x32_bf16 v[196:199], v[236:239], v[44:47], v[196:199]
    v_mov_b32_dpp v227, v147 row_ror:8 row_mask:0xf bank_mask:0xc
    v_mfma_f32_16x16x32_bf16 v[168:171], v[240:243], v[36:39], v[168:171]
    ds_read_b64_tr_b16 v[236:237], v206 offset:40960
    ds_read_b64_tr_b16 v[238:239], v206 offset:43008
    v_mov_b32_dpp v146, v253 row_ror:8 row_mask:0xf bank_mask:0x3
    v_mfma_f32_16x16x32_bf16 v[184:187], v[240:243], v[40:43], v[184:187]
    v_mfma_f32_16x16x32_bf16 v[200:203], v[240:243], v[44:47], v[200:203]
    v_mov_b32_dpp v147, v254 row_ror:8 row_mask:0xf bank_mask:0x3
    s_waitcnt lgkmcnt(2)
    v_mfma_f32_16x16x32_bf16 v[156:159], v[228:231], v[48:51], v[156:159]
    ds_read_b64_tr_b16 v[240:241], v207 offset:40960
    ds_read_b64_tr_b16 v[242:243], v207 offset:43008
    v_permlane16_swap_b32 v148, v150
    v_mfma_f32_16x16x32_bf16 v[172:175], v[228:231], v[52:55], v[172:175]
    v_mfma_f32_16x16x32_bf16 v[188:191], v[228:231], v[56:59], v[188:191]
    v_permlane16_swap_b32 v149, v151
    s_add_u32 s42, s25, 12416
    buffer_load_dwordx4 v[16:19], v211, s[8:11], s42 offen nt
    v_mfma_f32_16x16x32_bf16 v[160:163], v[232:235], v[48:51], v[160:163]
    ds_read_b64_tr_b16 v[228:229], v204 offset:45056
    ds_read_b64_tr_b16 v[230:231], v204 offset:47104
    v_permlane16_swap_b32 v152, v154
    v_mfma_f32_16x16x32_bf16 v[176:179], v[232:235], v[52:55], v[176:179]
    v_mfma_f32_16x16x32_bf16 v[192:195], v[232:235], v[56:59], v[192:195]
    v_permlane16_swap_b32 v153, v155
    s_waitcnt lgkmcnt(2)
    v_mfma_f32_16x16x32_bf16 v[164:167], v[236:239], v[48:51], v[164:167]
    ds_read_b64_tr_b16 v[232:233], v205 offset:45056
    ds_read_b64_tr_b16 v[234:235], v205 offset:47104
    v_mov_b32 v253, v148
    v_mfma_f32_16x16x32_bf16 v[180:183], v[236:239], v[52:55], v[180:183]
    v_mfma_f32_16x16x32_bf16 v[196:199], v[236:239], v[56:59], v[196:199]
    v_mov_b32 v254, v149
    s_add_u32 s42, s25, 15488
    buffer_load_dwordx4 v[20:23], v211, s[8:11], s42 offen nt
    v_mfma_f32_16x16x32_bf16 v[168:171], v[240:243], v[48:51], v[168:171]
    ds_read_b64_tr_b16 v[236:237], v206 offset:45056
    ds_read_b64_tr_b16 v[238:239], v206 offset:47104
    v_mov_b32_dpp v148, v152 row_ror:8 row_mask:0xf bank_mask:0xc
    v_mfma_f32_16x16x32_bf16 v[184:187], v[240:243], v[52:55], v[184:187]
    v_mfma_f32_16x16x32_bf16 v[200:203], v[240:243], v[56:59], v[200:203]
    v_mov_b32_dpp v149, v153 row_ror:8 row_mask:0xf bank_mask:0xc
    s_waitcnt lgkmcnt(2)
    v_mfma_f32_16x16x32_bf16 v[156:159], v[228:231], v[60:63], v[156:159]
    ds_read_b64_tr_b16 v[240:241], v207 offset:45056
    ds_read_b64_tr_b16 v[242:243], v207 offset:47104
    v_mov_b32_dpp v152, v253 row_ror:8 row_mask:0xf bank_mask:0x3
    v_mfma_f32_16x16x32_bf16 v[172:175], v[228:231], v[64:67], v[172:175]
    v_mfma_f32_16x16x32_bf16 v[188:191], v[228:231], v[68:71], v[188:191]
    v_mov_b32_dpp v153, v254 row_ror:8 row_mask:0xf bank_mask:0x3
    s_add_u32 s42, s25, 12544
    buffer_load_dwordx4 v[24:27], v211, s[8:11], s42 offen nt
    v_mfma_f32_16x16x32_bf16 v[160:163], v[232:235], v[60:63], v[160:163]
    v_add_u32 v204, 0x18000, v204
    v_add_u32 v205, 0x18000, v205
    v_add_u32 v206, 0x18000, v206
    v_add_u32 v207, 0x18000, v207
    ds_read_b64_tr_b16 v[228:229], v204 offset:24576
    ds_read_b64_tr_b16 v[230:231], v204 offset:26624
    v_mov_b32 v253, v150
    v_mfma_f32_16x16x32_bf16 v[176:179], v[232:235], v[64:67], v[176:179]
    v_mfma_f32_16x16x32_bf16 v[192:195], v[232:235], v[68:71], v[192:195]
    v_mov_b32 v254, v151
    s_waitcnt lgkmcnt(2)
    v_mfma_f32_16x16x32_bf16 v[164:167], v[236:239], v[60:63], v[164:167]
    ds_read_b64_tr_b16 v[232:233], v205 offset:24576
    ds_read_b64_tr_b16 v[234:235], v205 offset:26624
    v_mov_b32_dpp v150, v154 row_ror:8 row_mask:0xf bank_mask:0xc
    v_mfma_f32_16x16x32_bf16 v[180:183], v[236:239], v[64:67], v[180:183]
    v_mfma_f32_16x16x32_bf16 v[196:199], v[236:239], v[68:71], v[196:199]
    v_mov_b32_dpp v151, v155 row_ror:8 row_mask:0xf bank_mask:0xc
    s_add_u32 s42, s25, 15616
    buffer_load_dwordx4 v[28:31], v211, s[8:11], s42 offen nt
    v_mfma_f32_16x16x32_bf16 v[168:171], v[240:243], v[60:63], v[168:171]
    ds_read_b64_tr_b16 v[236:237], v206 offset:24576
    ds_read_b64_tr_b16 v[238:239], v206 offset:26624
    v_mov_b32_dpp v154, v253 row_ror:8 row_mask:0xf bank_mask:0x3
    v_mfma_f32_16x16x32_bf16 v[184:187], v[240:243], v[64:67], v[184:187]
    v_mfma_f32_16x16x32_bf16 v[200:203], v[240:243], v[68:71], v[200:203]
    v_mov_b32_dpp v155, v254 row_ror:8 row_mask:0xf bank_mask:0x3
    s_waitcnt vmcnt(22)
    s_barrier
    s_waitcnt lgkmcnt(2)
    v_mfma_f32_16x16x32_bf16 v[156:159], v[228:231], v[72:75], v[156:159]
    ds_read_b64_tr_b16 v[240:241], v207 offset:24576
    ds_read_b64_tr_b16 v[242:243], v207 offset:26624
    v_mfma_f32_16x16x32_bf16 v[172:175], v[228:231], v[76:79], v[172:175]
    v_mfma_f32_16x16x32_bf16 v[188:191], v[228:231], v[80:83], v[188:191]
    s_add_u32 m0, s30, 24576
    s_add_u32 s31, s25, 24576
    buffer_load_dwordx4 v208, s[12:15], s31 offen offset:0 nt lds
    buffer_load_dwordx4 v209, s[12:15], s31 offen offset:1024 nt lds
    buffer_load_dwordx4 v210, s[12:15], s31 offen offset:2048 nt lds
    v_mfma_f32_16x16x32_bf16 v[160:163], v[232:235], v[72:75], v[160:163]
    ds_read_b64_tr_b16 v[228:229], v204 offset:28672
    ds_read_b64_tr_b16 v[230:231], v204 offset:30720
    v_mfma_f32_16x16x32_bf16 v[176:179], v[232:235], v[76:79], v[176:179]
    v_mfma_f32_16x16x32_bf16 v[192:195], v[232:235], v[80:83], v[192:195]
    s_waitcnt lgkmcnt(2)
    v_mfma_f32_16x16x32_bf16 v[164:167], v[236:239], v[72:75], v[164:167]
    ds_read_b64_tr_b16 v[232:233], v205 offset:28672
    ds_read_b64_tr_b16 v[234:235], v205 offset:30720
    v_mfma_f32_16x16x32_bf16 v[180:183], v[236:239], v[76:79], v[180:183]
    v_mfma_f32_16x16x32_bf16 v[196:199], v[236:239], v[80:83], v[196:199]
    v_mfma_f32_16x16x32_bf16 v[168:171], v[240:243], v[72:75], v[168:171]
    ds_read_b64_tr_b16 v[236:237], v206 offset:28672
    ds_read_b64_tr_b16 v[238:239], v206 offset:30720
    v_mfma_f32_16x16x32_bf16 v[184:187], v[240:243], v[76:79], v[184:187]
    v_mfma_f32_16x16x32_bf16 v[200:203], v[240:243], v[80:83], v[200:203]
    s_waitcnt lgkmcnt(2)
    v_mfma_f32_16x16x32_bf16 v[156:159], v[228:231], v[84:87], v[156:159]
    ds_read_b64_tr_b16 v[240:241], v207 offset:28672
    ds_read_b64_tr_b16 v[242:243], v207 offset:30720
    v_mfma_f32_16x16x32_bf16 v[172:175], v[228:231], v[88:91], v[172:175]
    v_mfma_f32_16x16x32_bf16 v[188:191], v[228:231], v[92:95], v[188:191]
    s_add_u32 s34, s49, 6144
    buffer_store_dwordx4 v[144:147], v212, s[20:23], s34 offen offset:3200
    v_mfma_f32_16x16x32_bf16 v[160:163], v[232:235], v[84:87], v[160:163]
    ds_read_b64_tr_b16 v[228:229], v204 offset:32768
    ds_read_b64_tr_b16 v[230:231], v204 offset:34816
    v_mfma_f32_16x16x32_bf16 v[176:179], v[232:235], v[88:91], v[176:179]
    v_mfma_f32_16x16x32_bf16 v[192:195], v[232:235], v[92:95], v[192:195]
    s_waitcnt lgkmcnt(2)
    v_mfma_f32_16x16x32_bf16 v[164:167], v[236:239], v[84:87], v[164:167]
    ds_read_b64_tr_b16 v[232:233], v205 offset:32768
    ds_read_b64_tr_b16 v[234:235], v205 offset:34816
    v_mfma_f32_16x16x32_bf16 v[180:183], v[236:239], v[88:91], v[180:183]
    v_mfma_f32_16x16x32_bf16 v[196:199], v[236:239], v[92:95], v[196:199]
    s_add_u32 s34, s49, 12288
    buffer_store_dwordx4 v[148:151], v212, s[20:23], s34 offen offset:128
    v_mfma_f32_16x16x32_bf16 v[168:171], v[240:243], v[84:87], v[168:171]
    ds_read_b64_tr_b16 v[236:237], v206 offset:32768
    ds_read_b64_tr_b16 v[238:239], v206 offset:34816
    v_mfma_f32_16x16x32_bf16 v[184:187], v[240:243], v[88:91], v[184:187]
    v_mfma_f32_16x16x32_bf16 v[200:203], v[240:243], v[92:95], v[200:203]
    s_waitcnt lgkmcnt(2)
    v_mfma_f32_16x16x32_bf16 v[156:159], v[228:231], v[96:99], v[156:159]
    ds_read_b64_tr_b16 v[240:241], v207 offset:32768
    ds_read_b64_tr_b16 v[242:243], v207 offset:34816
    v_mfma_f32_16x16x32_bf16 v[172:175], v[228:231], v[100:103], v[172:175]
    v_mfma_f32_16x16x32_bf16 v[188:191], v[228:231], v[104:107], v[188:191]
    s_add_u32 s34, s26, 0
    buffer_store_dwordx4 v[216:219], v212, s[20:23], s34 offen offset:128
    v_mfma_f32_16x16x32_bf16 v[160:163], v[232:235], v[96:99], v[160:163]
    ds_read_b64_tr_b16 v[228:229], v204 offset:36864
    ds_read_b64_tr_b16 v[230:231], v204 offset:38912
    v_mfma_f32_16x16x32_bf16 v[176:179], v[232:235], v[100:103], v[176:179]
    v_mfma_f32_16x16x32_bf16 v[192:195], v[232:235], v[104:107], v[192:195]
    s_waitcnt lgkmcnt(2)
    v_mfma_f32_16x16x32_bf16 v[164:167], v[236:239], v[96:99], v[164:167]
    ds_read_b64_tr_b16 v[232:233], v205 offset:36864
    ds_read_b64_tr_b16 v[234:235], v205 offset:38912
    v_mfma_f32_16x16x32_bf16 v[180:183], v[236:239], v[100:103], v[180:183]
    v_mfma_f32_16x16x32_bf16 v[196:199], v[236:239], v[104:107], v[196:199]
    v_mfma_f32_16x16x32_bf16 v[168:171], v[240:243], v[96:99], v[168:171]
    ds_read_b64_tr_b16 v[236:237], v206 offset:36864
    ds_read_b64_tr_b16 v[238:239], v206 offset:38912
    v_mfma_f32_16x16x32_bf16 v[184:187], v[240:243], v[100:103], v[184:187]
    v_mfma_f32_16x16x32_bf16 v[200:203], v[240:243], v[104:107], v[200:203]
    s_waitcnt lgkmcnt(2)
    v_mfma_f32_16x16x32_bf16 v[156:159], v[228:231], v[108:111], v[156:159]
    ds_read_b64_tr_b16 v[240:241], v207 offset:36864
    ds_read_b64_tr_b16 v[242:243], v207 offset:38912
    v_mfma_f32_16x16x32_bf16 v[172:175], v[228:231], v[112:115], v[172:175]
    v_mfma_f32_16x16x32_bf16 v[188:191], v[228:231], v[116:119], v[188:191]
    s_add_u32 s34, s26, 0
    buffer_store_dwordx4 v[220:223], v212, s[20:23], s34 offen offset:3200
    v_mfma_f32_16x16x32_bf16 v[160:163], v[232:235], v[108:111], v[160:163]
    ds_read_b64_tr_b16 v[228:229], v204 offset:40960
    ds_read_b64_tr_b16 v[230:231], v204 offset:43008
    v_mfma_f32_16x16x32_bf16 v[176:179], v[232:235], v[112:115], v[176:179]
    v_mfma_f32_16x16x32_bf16 v[192:195], v[232:235], v[116:119], v[192:195]
    s_waitcnt lgkmcnt(2)
    v_mfma_f32_16x16x32_bf16 v[164:167], v[236:239], v[108:111], v[164:167]
    ds_read_b64_tr_b16 v[232:233], v205 offset:40960
    ds_read_b64_tr_b16 v[234:235], v205 offset:43008
    v_mfma_f32_16x16x32_bf16 v[180:183], v[236:239], v[112:115], v[180:183]
    v_mfma_f32_16x16x32_bf16 v[196:199], v[236:239], v[116:119], v[196:199]
    v_mfma_f32_16x16x32_bf16 v[168:171], v[240:243], v[108:111], v[168:171]
    ds_read_b64_tr_b16 v[236:237], v206 offset:40960
    ds_read_b64_tr_b16 v[238:239], v206 offset:43008
    v_mfma_f32_16x16x32_bf16 v[184:187], v[240:243], v[112:115], v[184:187]
    v_mfma_f32_16x16x32_bf16 v[200:203], v[240:243], v[116:119], v[200:203]
    s_waitcnt lgkmcnt(2)
    v_mfma_f32_16x16x32_bf16 v[156:159], v[228:231], v[120:123], v[156:159]
    ds_read_b64_tr_b16 v[240:241], v207 offset:40960
    ds_read_b64_tr_b16 v[242:243], v207 offset:43008
    v_mfma_f32_16x16x32_bf16 v[172:175], v[228:231], v[124:127], v[172:175]
    v_mfma_f32_16x16x32_bf16 v[188:191], v[228:231], v[128:131], v[188:191]
    s_add_u32 s34, s26, 6144
    buffer_store_dwordx4 v[224:227], v212, s[20:23], s34 offen offset:128
    v_mfma_f32_16x16x32_bf16 v[160:163], v[232:235], v[120:123], v[160:163]
    ds_read_b64_tr_b16 v[228:229], v204 offset:45056
    ds_read_b64_tr_b16 v[230:231], v204 offset:47104
    v_mfma_f32_16x16x32_bf16 v[176:179], v[232:235], v[124:127], v[176:179]
    v_mfma_f32_16x16x32_bf16 v[192:195], v[232:235], v[128:131], v[192:195]
    s_waitcnt lgkmcnt(2)
    v_mfma_f32_16x16x32_bf16 v[164:167], v[236:239], v[120:123], v[164:167]
    ds_read_b64_tr_b16 v[232:233], v205 offset:45056
    ds_read_b64_tr_b16 v[234:235], v205 offset:47104
    v_mfma_f32_16x16x32_bf16 v[180:183], v[236:239], v[124:127], v[180:183]
    v_mfma_f32_16x16x32_bf16 v[196:199], v[236:239], v[128:131], v[196:199]
    v_mfma_f32_16x16x32_bf16 v[168:171], v[240:243], v[120:123], v[168:171]
    ds_read_b64_tr_b16 v[236:237], v206 offset:45056
    ds_read_b64_tr_b16 v[238:239], v206 offset:47104
    v_mfma_f32_16x16x32_bf16 v[184:187], v[240:243], v[124:127], v[184:187]
    v_mfma_f32_16x16x32_bf16 v[200:203], v[240:243], v[128:131], v[200:203]
    s_waitcnt lgkmcnt(2)
    v_mfma_f32_16x16x32_bf16 v[156:159], v[228:231], v[132:135], v[156:159]
    ds_read_b64_tr_b16 v[240:241], v207 offset:45056
    ds_read_b64_tr_b16 v[242:243], v207 offset:47104
    v_mfma_f32_16x16x32_bf16 v[172:175], v[228:231], v[136:139], v[172:175]
    v_mfma_f32_16x16x32_bf16 v[188:191], v[228:231], v[140:143], v[188:191]
    s_add_u32 s34, s49, 12288
    buffer_store_dwordx4 v[152:155], v212, s[20:23], s34 offen offset:3200
    v_mfma_f32_16x16x32_bf16 v[160:163], v[232:235], v[132:135], v[160:163]
    v_mfma_f32_16x16x32_bf16 v[176:179], v[232:235], v[136:139], v[176:179]
    v_mfma_f32_16x16x32_bf16 v[192:195], v[232:235], v[140:143], v[192:195]
    s_waitcnt lgkmcnt(0)
    v_mfma_f32_16x16x32_bf16 v[164:167], v[236:239], v[132:135], v[164:167]
    v_mul_f32 v156, v156, v244
    v_mul_f32 v157, v157, v244
    v_mul_f32 v158, v158, v244
    v_mul_f32 v159, v159, v244
    v_cvt_pk_bf16_f32 v96, v156, v157
    v_mfma_f32_16x16x32_bf16 v[180:183], v[236:239], v[136:139], v[180:183]
    v_cvt_pk_bf16_f32 v97, v158, v159
    v_mul_f32 v172, v172, v246
    v_mul_f32 v173, v173, v246
    v_mul_f32 v174, v174, v246
    v_mfma_f32_16x16x32_bf16 v[196:199], v[236:239], v[140:143], v[196:199]
    v_mul_f32 v175, v175, v246
    v_cvt_pk_bf16_f32 v104, v172, v173
    v_cvt_pk_bf16_f32 v105, v174, v175
    v_mul_f32 v188, v188, v248
    v_mul_f32 v189, v189, v248
    v_mfma_f32_16x16x32_bf16 v[168:171], v[240:243], v[132:135], v[168:171]
    v_mul_f32 v190, v190, v248
    v_mul_f32 v191, v191, v248
    v_cvt_pk_bf16_f32 v112, v188, v189
    v_cvt_pk_bf16_f32 v113, v190, v191
    v_mfma_f32_16x16x32_bf16 v[184:187], v[240:243], v[136:139], v[184:187]
    v_mul_f32 v160, v160, v244
    v_mul_f32 v161, v161, v244
    v_mul_f32 v162, v162, v244
    v_mul_f32 v163, v163, v244
    v_cvt_pk_bf16_f32 v98, v160, v161
    v_mfma_f32_16x16x32_bf16 v[200:203], v[240:243], v[140:143], v[200:203]
    v_cvt_pk_bf16_f32 v99, v162, v163
    v_mul_f32 v176, v176, v246
    v_mul_f32 v177, v177, v246
    v_mul_f32 v178, v178, v246
L_entry:
    ds_read_b128 v[228:231], v250 offset:0
    ds_read_b128 v[232:235], v251 offset:0
    ds_read_b128 v[236:239], v250 offset:128
    s_mov_b32 s24, s25
    s_mov_b32 s27, s26
    v_mul_f32 v179, v179, v246
    v_cvt_pk_bf16_f32 v106, v176, v177
    v_cvt_pk_bf16_f32 v107, v178, v179
    v_mul_f32 v192, v192, v248
    v_mul_f32 v193, v193, v248
    v_mul_f32 v194, v194, v248
    v_mul_f32 v195, v195, v248
    v_cvt_pk_bf16_f32 v114, v192, v193
    v_cvt_pk_bf16_f32 v115, v194, v195
    v_mov_b32 v132, v208
    v_mov_b32 v133, v209
    v_mov_b32 v134, v210
    v_mov_b32 v135, v212
    v_mov_b32 v136, v211
    v_and_b32 v253, 0x37, v213
    v_lshl_add_u32 v253, v253, 4, s30
    v_bfe_u32 v254, v213, 3, 1
    v_lshl_add_u32 v255, v254, 10, v253
    v_mul_u32_u24 v254, 0x6000, v254
    v_add_u32 v253, v253, v254
    v_add_u32 v255, 0x18000, v255
    v_add_u32 v253, 0xc000, v253
    s_sub_u32 s31, s43, s30
    s_add_u32 s31, s31, 49152
    v_add_u32 v254, s31, v255
    v_pk_mul_f32 v[164:165], v[164:165], v[244:245] op_sel_hi:[1,0]
    v_pk_mul_f32 v[166:167], v[166:167], v[244:245] op_sel_hi:[1,0]
    v_cvt_pk_bf16_f32 v100, v164, v165
    v_cvt_pk_bf16_f32 v101, v166, v167
    v_pk_mul_f32 v[180:181], v[180:181], v[246:247] op_sel_hi:[1,0]
    v_pk_mul_f32 v[182:183], v[182:183], v[246:247] op_sel_hi:[1,0]
    v_cvt_pk_bf16_f32 v108, v180, v181
    v_cvt_pk_bf16_f32 v109, v182, v183
    v_pk_mul_f32 v[196:197], v[196:197], v[248:249] op_sel_hi:[1,0]
    v_pk_mul_f32 v[198:199], v[198:199], v[248:249] op_sel_hi:[1,0]
    v_cvt_pk_bf16_f32 v116, v196, v197
    v_cvt_pk_bf16_f32 v117, v198, v199
    v_pk_mul_f32 v[168:169], v[168:169], v[244:245] op_sel_hi:[1,0]
    v_pk_mul_f32 v[170:171], v[170:171], v[244:245] op_sel_hi:[1,0]
    v_cvt_pk_bf16_f32 v102, v168, v169
    v_cvt_pk_bf16_f32 v103, v170, v171
    v_pk_mul_f32 v[184:185], v[184:185], v[246:247] op_sel_hi:[1,0]
    v_pk_mul_f32 v[186:187], v[186:187], v[246:247] op_sel_hi:[1,0]
    v_cvt_pk_bf16_f32 v110, v184, v185
    v_cvt_pk_bf16_f32 v111, v186, v187
    v_pk_mul_f32 v[200:201], v[200:201], v[248:249] op_sel_hi:[1,0]
    v_pk_mul_f32 v[202:203], v[202:203], v[248:249] op_sel_hi:[1,0]
    v_cvt_pk_bf16_f32 v118, v200, v201
    v_cvt_pk_bf16_f32 v119, v202, v203
    s_mov_b32 s26, s25
    s_mul_i32 s25, s35, 147456
    s_cmp_ge_u32 s35, 1024
    s_cselect_b32 s25, 0x10000000, s25
    s_add_u32 s35, s35, 256
    s_cmp_eq_u32 s25, 0x10000000
    s_cselect_b32 s49, s26, 0x10000000
    s_waitcnt vmcnt(9)
    ds_read_b128 v[156:159], v253 offset:0
    ds_read_b128 v[160:163], v253 offset:128
    ds_read_b128 v[164:167], v253 offset:1024
    ds_read_b128 v[168:171], v253 offset:1152
    ds_read_b128 v[172:175], v253 offset:2048
    ds_read_b128 v[176:179], v253 offset:2176
    ds_read_b128 v[180:183], v255 offset:0
    ds_read_b128 v[184:187], v255 offset:128
    ds_read_b128 v[188:191], v254 offset:0
    ds_read_b128 v[192:195], v254 offset:128
    v_pk_mov_b32 v[196:197], v[0:1], v[0:1] op_sel:[0,1]
    v_pk_mov_b32 v[198:199], v[2:3], v[2:3] op_sel:[0,1]
    v_pk_mov_b32 v[200:201], v[4:5], v[4:5] op_sel:[0,1]
    v_pk_mov_b32 v[202:203], v[6:7], v[6:7] op_sel:[0,1]
    v_mov_b32_dpp v196, v4 row_ror:8 row_mask:0xf bank_mask:0xc
    v_mov_b32_dpp v197, v5 row_ror:8 row_mask:0xf bank_mask:0xc
    v_mov_b32_dpp v198, v6 row_ror:8 row_mask:0xf bank_mask:0xc
    v_mov_b32_dpp v199, v7 row_ror:8 row_mask:0xf bank_mask:0xc
    v_mov_b32_dpp v200, v0 row_ror:8 row_mask:0xf bank_mask:0x3
    v_mov_b32_dpp v201, v1 row_ror:8 row_mask:0xf bank_mask:0x3
    v_mov_b32_dpp v202, v2 row_ror:8 row_mask:0xf bank_mask:0x3
    v_mov_b32_dpp v203, v3 row_ror:8 row_mask:0xf bank_mask:0x3
    v_pk_mov_b32 v[204:205], v[8:9], v[8:9] op_sel:[0,1]
    v_pk_mov_b32 v[206:207], v[10:11], v[10:11] op_sel:[0,1]
    v_pk_mov_b32 v[208:209], v[12:13], v[12:13] op_sel:[0,1]
    v_pk_mov_b32 v[210:211], v[14:15], v[14:15] op_sel:[0,1]
    v_mov_b32_dpp v204, v12 row_ror:8 row_mask:0xf bank_mask:0xc
    v_mov_b32_dpp v205, v13 row_ror:8 row_mask:0xf bank_mask:0xc
    v_mov_b32_dpp v206, v14 row_ror:8 row_mask:0xf bank_mask:0xc
    v_mov_b32_dpp v207, v15 row_ror:8 row_mask:0xf bank_mask:0xc
    v_mov_b32_dpp v208, v8 row_ror:8 row_mask:0xf bank_mask:0x3
    v_mov_b32_dpp v209, v9 row_ror:8 row_mask:0xf bank_mask:0x3
    v_mov_b32_dpp v210, v10 row_ror:8 row_mask:0xf bank_mask:0x3
    v_mov_b32_dpp v211, v11 row_ror:8 row_mask:0xf bank_mask:0x3
    v_pk_mov_b32 v[212:213], v[16:17], v[16:17] op_sel:[0,1]
    v_pk_mov_b32 v[214:215], v[18:19], v[18:19] op_sel:[0,1]
    v_pk_mov_b32 v[216:217], v[20:21], v[20:21] op_sel:[0,1]
    v_pk_mov_b32 v[218:219], v[22:23], v[22:23] op_sel:[0,1]
    v_mov_b32_dpp v212, v20 row_ror:8 row_mask:0xf bank_mask:0xc
    v_mov_b32_dpp v213, v21 row_ror:8 row_mask:0xf bank_mask:0xc
    v_mov_b32_dpp v214, v22 row_ror:8 row_mask:0xf bank_mask:0xc
    v_mov_b32_dpp v215, v23 row_ror:8 row_mask:0xf bank_mask:0xc
    v_mov_b32_dpp v216, v16 row_ror:8 row_mask:0xf bank_mask:0x3
    v_mov_b32_dpp v217, v17 row_ror:8 row_mask:0xf bank_mask:0x3
    v_mov_b32_dpp v218, v18 row_ror:8 row_mask:0xf bank_mask:0x3
    v_mov_b32_dpp v219, v19 row_ror:8 row_mask:0xf bank_mask:0x3
    v_pk_mov_b32 v[220:221], v[24:25], v[24:25] op_sel:[0,1]
    v_pk_mov_b32 v[222:223], v[26:27], v[26:27] op_sel:[0,1]
    v_pk_mov_b32 v[224:225], v[28:29], v[28:29] op_sel:[0,1]
    v_pk_mov_b32 v[226:227], v[30:31], v[30:31] op_sel:[0,1]
    v_mov_b32_dpp v220, v28 row_ror:8 row_mask:0xf bank_mask:0xc
    v_mov_b32_dpp v221, v29 row_ror:8 row_mask:0xf bank_mask:0xc
    v_mov_b32_dpp v222, v30 row_ror:8 row_mask:0xf bank_mask:0xc
    v_mov_b32_dpp v223, v31 row_ror:8 row_mask:0xf bank_mask:0xc
    v_mov_b32_dpp v224, v24 row_ror:8 row_mask:0xf bank_mask:0x3
    v_mov_b32_dpp v225, v25 row_ror:8 row_mask:0xf bank_mask:0x3
    v_mov_b32_dpp v226, v26 row_ror:8 row_mask:0xf bank_mask:0x3
    v_mov_b32_dpp v227, v27 row_ror:8 row_mask:0xf bank_mask:0x3
    s_waitcnt lgkmcnt(0)
    s_barrier
    s_add_u32 s28, s28, 1
    s_cmp_le_u32 s28, 4
    s_cbranch_scc1 L_head
    v_permlane16_swap_b32 v96, v98
    v_permlane16_swap_b32 v97, v99
    v_permlane16_swap_b32 v100, v102
    v_permlane16_swap_b32 v101, v103
    v_mov_b32 v253, v96
    v_mov_b32 v254, v97
    v_mov_b32_dpp v96, v100 row_ror:8 row_mask:0xf bank_mask:0xc
    v_mov_b32_dpp v97, v101 row_ror:8 row_mask:0xf bank_mask:0xc
    v_mov_b32_dpp v100, v253 row_ror:8 row_mask:0xf bank_mask:0x3
    v_mov_b32_dpp v101, v254 row_ror:8 row_mask:0xf bank_mask:0x3
    v_mov_b32 v253, v98
    v_mov_b32 v254, v99
    v_mov_b32_dpp v98, v102 row_ror:8 row_mask:0xf bank_mask:0xc
    v_mov_b32_dpp v99, v103 row_ror:8 row_mask:0xf bank_mask:0xc
    v_mov_b32_dpp v102, v253 row_ror:8 row_mask:0xf bank_mask:0x3
    v_mov_b32_dpp v103, v254 row_ror:8 row_mask:0xf bank_mask:0x3
    v_permlane16_swap_b32 v104, v106
    v_permlane16_swap_b32 v105, v107
    v_permlane16_swap_b32 v108, v110
    v_permlane16_swap_b32 v109, v111
    v_mov_b32 v253, v104
    v_mov_b32 v254, v105
    v_mov_b32_dpp v104, v108 row_ror:8 row_mask:0xf bank_mask:0xc
    v_mov_b32_dpp v105, v109 row_ror:8 row_mask:0xf bank_mask:0xc
    v_mov_b32_dpp v108, v253 row_ror:8 row_mask:0xf bank_mask:0x3
    v_mov_b32_dpp v109, v254 row_ror:8 row_mask:0xf bank_mask:0x3
    v_mov_b32 v253, v106
    v_mov_b32 v254, v107
    v_mov_b32_dpp v106, v110 row_ror:8 row_mask:0xf bank_mask:0xc
    v_mov_b32_dpp v107, v111 row_ror:8 row_mask:0xf bank_mask:0xc
    v_mov_b32_dpp v110, v253 row_ror:8 row_mask:0xf bank_mask:0x3
    v_mov_b32_dpp v111, v254 row_ror:8 row_mask:0xf bank_mask:0x3
    v_permlane16_swap_b32 v112, v114
    v_permlane16_swap_b32 v113, v115
    v_permlane16_swap_b32 v116, v118
    v_permlane16_swap_b32 v117, v119
    v_mov_b32 v253, v112
    v_mov_b32 v254, v113
    v_mov_b32_dpp v112, v116 row_ror:8 row_mask:0xf bank_mask:0xc
    v_mov_b32_dpp v113, v117 row_ror:8 row_mask:0xf bank_mask:0xc
    v_mov_b32_dpp v116, v253 row_ror:8 row_mask:0xf bank_mask:0x3
    v_mov_b32_dpp v117, v254 row_ror:8 row_mask:0xf bank_mask:0x3
    v_mov_b32 v253, v114
    v_mov_b32 v254, v115
    v_mov_b32_dpp v114, v118 row_ror:8 row_mask:0xf bank_mask:0xc
    v_mov_b32_dpp v115, v119 row_ror:8 row_mask:0xf bank_mask:0xc
    v_mov_b32_dpp v118, v253 row_ror:8 row_mask:0xf bank_mask:0x3
    v_mov_b32_dpp v119, v254 row_ror:8 row_mask:0xf bank_mask:0x3
    s_add_u32 s34, s27, 0
    buffer_store_dwordx4 v[96:99], v135, s[20:23], s34 offen offset:256
    s_add_u32 s34, s27, 0
    buffer_store_dwordx4 v[100:103], v135, s[20:23], s34 offen offset:3328
    s_add_u32 s34, s27, 6144
    buffer_store_dwordx4 v[104:107], v135, s[20:23], s34 offen offset:256
    s_add_u32 s34, s27, 6144
    buffer_store_dwordx4 v[108:111], v135, s[20:23], s34 offen offset:3328
    s_add_u32 s34, s27, 12288
    buffer_store_dwordx4 v[112:115], v135, s[20:23], s34 offen offset:256
    s_add_u32 s34, s27, 12288
    buffer_store_dwordx4 v[116:119], v135, s[20:23], s34 offen offset:3328
L_end:
    s_endpgm
L_slow:
    s_waitcnt vmcnt(0) lgkmcnt(0)
    s_mov_b64 s[44:45], -1
    s_nop 7
    s_nop 7
    v_mbcnt_lo_u32_b32 v253, -1, 0
    v_mbcnt_hi_u32_b32 v253, -1, v253
    v_lshrrev_b32 v254, 4, v253
    v_and_b32 v253, 15, v253
    v_mul_u32_u24 v253, 384, v253
    v_lshl_add_u32 v255, v254, 4, v253
    s_mul_i32 s31, s30, 6
    s_add_u32 s31, s31, s24
    buffer_load_dwordx4 v[156:159], v255, s[8:11], s31 offen offset:0
    buffer_load_dwordx4 v[160:163], v255, s[8:11], s31 offen offset:64
    buffer_load_dwordx4 v[164:167], v255, s[8:11], s31 offen offset:128
    buffer_load_dwordx4 v[168:171], v255, s[8:11], s31 offen offset:192
    buffer_load_dwordx4 v[172:175], v255, s[8:11], s31 offen offset:256
    buffer_load_dwordx4 v[176:179], v255, s[8:11], s31 offen offset:320
    s_add_u32 s31, s31, 6144
    buffer_load_dwordx4 v[180:183], v255, s[8:11], s31 offen offset:0
    buffer_load_dwordx4 v[184:187], v255, s[8:11], s31 offen offset:64
    buffer_load_dwordx4 v[188:191], v255, s[8:11], s31 offen offset:128
    buffer_load_dwordx4 v[192:195], v255, s[8:11], s31 offen offset:192
    buffer_load_dwordx4 v[196:199], v255, s[8:11], s31 offen offset:256
    buffer_load_dwordx4 v[200:203], v255, s[8:11], s31 offen offset:320
    s_add_u32 s31, s31, 6144
    buffer_load_dwordx4 v[204:207], v255, s[8:11], s31 offen offset:0
    buffer_load_dwordx4 v[208:211], v255, s[8:11], s31 offen offset:64
    buffer_load_dwordx4 v[212:215], v255, s[8:11], s31 offen offset:128
    buffer_load_dwordx4 v[216:219], v255, s[8:11], s31 offen offset:192
    buffer_load_dwordx4 v[220:223], v255, s[8:11], s31 offen offset:256
    buffer_load_dwordx4 v[224:227], v255, s[8:11], s31 offen offset:320
    s_add_u32 s31, s31, 6144
    v_mov_b32 v245, 0xff800000
    v_mov_b32 v247, 0xff800000
    v_mov_b32 v249, 0xff800000
    s_mov_b32 s31, s24
    s_mov_b32 s34, 0
L_slow_a:
    buffer_load_dwordx4 v[228:231], v255, s[12:15], s31 offen offset:0
    buffer_load_dwordx4 v[232:235], v255, s[12:15], s31 offen offset:64
    buffer_load_dwordx4 v[236:239], v255, s[12:15], s31 offen offset:128
    s_waitcnt vmcnt(0)
    v_mfma_f32_16x16x32_bf16 v[144:147], v[228:231], v[156:159], 0
    v_mfma_f32_16x16x32_bf16 v[148:151], v[228:231], v[180:183], 0
    v_mfma_f32_16x16x32_bf16 v[152:155], v[228:231], v[204:207], 0
    v_mfma_f32_16x16x32_bf16 v[144:147], v[232:235], v[160:163], v[144:147]
    v_mfma_f32_16x16x32_bf16 v[148:151], v[232:235], v[184:187], v[148:151]
    v_mfma_f32_16x16x32_bf16 v[152:155], v[232:235], v[208:211], v[152:155]
    v_mfma_f32_16x16x32_bf16 v[144:147], v[236:239], v[164:167], v[144:147]
    v_mfma_f32_16x16x32_bf16 v[148:151], v[236:239], v[188:191], v[148:151]
    v_mfma_f32_16x16x32_bf16 v[152:155], v[236:239], v[212:215], v[152:155]
    s_nop 7
    s_nop 7
    s_nop 7
    buffer_load_dwordx4 v[228:231], v255, s[12:15], s31 offen offset:192
    buffer_load_dwordx4 v[232:235], v255, s[12:15], s31 offen offset:256
    buffer_load_dwordx4 v[236:239], v255, s[12:15], s31 offen offset:320
    s_waitcnt vmcnt(0)
    v_mfma_f32_16x16x32_bf16 v[144:147], v[228:231], v[168:171], v[144:147]
    v_mfma_f32_16x16x32_bf16 v[148:151], v[228:231], v[192:195], v[148:151]
    v_mfma_f32_16x16x32_bf16 v[152:155], v[228:231], v[216:219], v[152:155]
    v_mfma_f32_16x16x32_bf16 v[144:147], v[232:235], v[172:175], v[144:147]
    v_mfma_f32_16x16x32_bf16 v[148:151], v[232:235], v[196:199], v[148:151]
    v_mfma_f32_16x16x32_bf16 v[152:155], v[232:235], v[220:223], v[152:155]
    v_mfma_f32_16x16x32_bf16 v[144:147], v[236:239], v[176:179], v[144:147]
    v_mfma_f32_16x16x32_bf16 v[148:151], v[236:239], v[200:203], v[148:151]
    v_mfma_f32_16x16x32_bf16 v[152:155], v[236:239], v[224:227], v[152:155]
    s_nop 7
    s_nop 7
    s_nop 7
    s_add_u32 s31, s31, 6144
    v_max3_f32 v245, v245, v144, v145
    v_max3_f32 v245, v245, v146, v147
    v_max3_f32 v247, v247, v148, v149
    v_max3_f32 v247, v247, v150, v151
    v_max3_f32 v249, v249, v152, v153
    v_max3_f32 v249, v249, v154, v155
    s_add_u32 s34, s34, 1
    s_cmp_lt_u32 s34, 24
    s_cbranch_scc1 L_slow_a
    v_mov_b32 v254, v245
    s_nop 1
    v_permlane16_swap_b32 v245, v254
    s_nop 1
    v_max_f32 v245, v245, v254
    v_mov_b32 v254, v245
    s_nop 1
    v_permlane32_swap_b32 v245, v254
    s_nop 1
    v_max_f32 v245, v245, v254
    v_mul_f32 v245, s29, v245
    v_mov_b32 v254, v247
    s_nop 1
    v_permlane16_swap_b32 v247, v254
    s_nop 1
    v_max_f32 v247, v247, v254
    v_mov_b32 v254, v247
    s_nop 1
    v_permlane32_swap_b32 v247, v254
    s_nop 1
    v_max_f32 v247, v247, v254
    v_mul_f32 v247, s29, v247
    v_mov_b32 v254, v249
    s_nop 1
    v_permlane16_swap_b32 v249, v254
    s_nop 1
    v_max_f32 v249, v249, v254
    v_mov_b32 v254, v249
    s_nop 1
    v_permlane32_swap_b32 v249, v254
    s_nop 1
    v_max_f32 v249, v249, v254
    v_mul_f32 v249, s29, v249
    s_mov_b32 s31, s24
    buffer_load_dwordx4 v[228:231], v255, s[12:15], s31 offen offset:0
    buffer_load_dwordx4 v[232:235], v255, s[12:15], s31 offen offset:64
    buffer_load_dwordx4 v[236:239], v255, s[12:15], s31 offen offset:128
    s_waitcnt vmcnt(0)
    v_mfma_f32_16x16x32_bf16 v[0:3], v[228:231], v[156:159], 0
    v_mfma_f32_16x16x32_bf16 v[4:7], v[228:231], v[180:183], 0
    v_mfma_f32_16x16x32_bf16 v[8:11], v[228:231], v[204:207], 0
    v_mfma_f32_16x16x32_bf16 v[0:3], v[232:235], v[160:163], v[0:3]
    v_mfma_f32_16x16x32_bf16 v[4:7], v[232:235], v[184:187], v[4:7]
    v_mfma_f32_16x16x32_bf16 v[8:11], v[232:235], v[208:211], v[8:11]
    v_mfma_f32_16x16x32_bf16 v[0:3], v[236:239], v[164:167], v[0:3]
    v_mfma_f32_16x16x32_bf16 v[4:7], v[236:239], v[188:191], v[4:7]
    v_mfma_f32_16x16x32_bf16 v[8:11], v[236:239], v[212:215], v[8:11]
    s_nop 7
    s_nop 7
    s_nop 7
    buffer_load_dwordx4 v[228:231], v255, s[12:15], s31 offen offset:192
    buffer_load_dwordx4 v[232:235], v255, s[12:15], s31 offen offset:256
    buffer_load_dwordx4 v[236:239], v255, s[12:15], s31 offen offset:320
    s_waitcnt vmcnt(0)
    v_mfma_f32_16x16x32_bf16 v[0:3], v[228:231], v[168:171], v[0:3]
    v_mfma_f32_16x16x32_bf16 v[4:7], v[228:231], v[192:195], v[4:7]
    v_mfma_f32_16x16x32_bf16 v[8:11], v[228:231], v[216:219], v[8:11]
    v_mfma_f32_16x16x32_bf16 v[0:3], v[232:235], v[172:175], v[0:3]
    v_mfma_f32_16x16x32_bf16 v[4:7], v[232:235], v[196:199], v[4:7]
    v_mfma_f32_16x16x32_bf16 v[8:11], v[232:235], v[220:223], v[8:11]
    v_mfma_f32_16x16x32_bf16 v[0:3], v[236:239], v[176:179], v[0:3]
    v_mfma_f32_16x16x32_bf16 v[4:7], v[236:239], v[200:203], v[4:7]
    v_mfma_f32_16x16x32_bf16 v[8:11], v[236:239], v[224:227], v[8:11]
    s_nop 7
    s_nop 7
    s_nop 7
    s_add_u32 s31, s31, 6144
    v_fma_f32 v0, v0, s29, -v245
    v_fma_f32 v1, v1, s29, -v245
    v_fma_f32 v2, v2, s29, -v245
    v_fma_f32 v3, v3, s29, -v245
    v_fma_f32 v4, v4, s29, -v247
    v_fma_f32 v5, v5, s29, -v247
    v_fma_f32 v6, v6, s29, -v247
    v_fma_f32 v7, v7, s29, -v247
    v_fma_f32 v8, v8, s29, -v249
    v_fma_f32 v9, v9, s29, -v249
    v_fma_f32 v10, v10, s29, -v249
    v_fma_f32 v11, v11, s29, -v249
    v_exp_f32 v0, v0
    v_exp_f32 v1, v1
    v_exp_f32 v2, v2
    v_exp_f32 v3, v3
    v_cvt_pk_bf16_f32 v0, v0, v1
    v_exp_f32 v4, v4
    v_exp_f32 v5, v5
    v_cvt_pk_bf16_f32 v1, v2, v3
    v_exp_f32 v6, v6
    v_exp_f32 v7, v7
    v_cvt_pk_bf16_f32 v4, v4, v5
    v_exp_f32 v8, v8
    v_exp_f32 v9, v9
    v_cvt_pk_bf16_f32 v5, v6, v7
    v_exp_f32 v10, v10
    v_exp_f32 v11, v11
    v_cvt_pk_bf16_f32 v8, v8, v9
    v_cvt_pk_bf16_f32 v9, v10, v11
    buffer_load_dwordx4 v[228:231], v255, s[12:15], s31 offen offset:0
    buffer_load_dwordx4 v[232:235], v255, s[12:15], s31 offen offset:64
    buffer_load_dwordx4 v[236:239], v255, s[12:15], s31 offen offset:128
    s_waitcnt vmcnt(0)
    v_mfma_f32_16x16x32_bf16 v[144:147], v[228:231], v[156:159], 0
    v_mfma_f32_16x16x32_bf16 v[148:151], v[228:231], v[180:183], 0
    v_mfma_f32_16x16x32_bf16 v[152:155], v[228:231], v[204:207], 0
    v_mfma_f32_16x16x32_bf16 v[144:147], v[232:235], v[160:163], v[144:147]
    v_mfma_f32_16x16x32_bf16 v[148:151], v[232:235], v[184:187], v[148:151]
    v_mfma_f32_16x16x32_bf16 v[152:155], v[232:235], v[208:211], v[152:155]
    v_mfma_f32_16x16x32_bf16 v[144:147], v[236:239], v[164:167], v[144:147]
    v_mfma_f32_16x16x32_bf16 v[148:151], v[236:239], v[188:191], v[148:151]
    v_mfma_f32_16x16x32_bf16 v[152:155], v[236:239], v[212:215], v[152:155]
    s_nop 7
    s_nop 7
    s_nop 7
    buffer_load_dwordx4 v[228:231], v255, s[12:15], s31 offen offset:192
    buffer_load_dwordx4 v[232:235], v255, s[12:15], s31 offen offset:256
    buffer_load_dwordx4 v[236:239], v255, s[12:15], s31 offen offset:320
    s_waitcnt vmcnt(0)
    v_mfma_f32_16x16x32_bf16 v[144:147], v[228:231], v[168:171], v[144:147]
    v_mfma_f32_16x16x32_bf16 v[148:151], v[228:231], v[192:195], v[148:151]
    v_mfma_f32_16x16x32_bf16 v[152:155], v[228:231], v[216:219], v[152:155]
    v_mfma_f32_16x16x32_bf16 v[144:147], v[232:235], v[172:175], v[144:147]
    v_mfma_f32_16x16x32_bf16 v[148:151], v[232:235], v[196:199], v[148:151]
    v_mfma_f32_16x16x32_bf16 v[152:155], v[232:235], v[220:223], v[152:155]
    v_mfma_f32_16x16x32_bf16 v[144:147], v[236:239], v[176:179], v[144:147]
    v_mfma_f32_16x16x32_bf16 v[148:151], v[236:239], v[200:203], v[148:151]
    v_mfma_f32_16x16x32_bf16 v[152:155], v[236:239], v[224:227], v[152:155]
    s_nop 7
    s_nop 7
    s_nop 7
    s_add_u32 s31, s31, 6144
    v_fma_f32 v144, v144, s29, -v245
    v_fma_f32 v145, v145, s29, -v245
    v_fma_f32 v146, v146, s29, -v245
    v_fma_f32 v147, v147, s29, -v245
    v_fma_f32 v148, v148, s29, -v247
    v_fma_f32 v149, v149, s29, -v247
    v_fma_f32 v150, v150, s29, -v247
    v_fma_f32 v151, v151, s29, -v247
    v_fma_f32 v152, v152, s29, -v249
    v_fma_f32 v153, v153, s29, -v249
    v_fma_f32 v154, v154, s29, -v249
    v_fma_f32 v155, v155, s29, -v249
    v_exp_f32 v144, v144
    v_exp_f32 v145, v145
    v_exp_f32 v146, v146
    v_exp_f32 v147, v147
    v_cvt_pk_bf16_f32 v2, v144, v145
    v_exp_f32 v148, v148
    v_exp_f32 v149, v149
    v_cvt_pk_bf16_f32 v3, v146, v147
    v_exp_f32 v150, v150
    v_exp_f32 v151, v151
    v_cvt_pk_bf16_f32 v6, v148, v149
    v_exp_f32 v152, v152
    v_exp_f32 v153, v153
    v_cvt_pk_bf16_f32 v7, v150, v151
    v_exp_f32 v154, v154
    v_exp_f32 v155, v155
    v_cvt_pk_bf16_f32 v10, v152, v153
    v_cvt_pk_bf16_f32 v11, v154, v155
    buffer_load_dwordx4 v[228:231], v255, s[12:15], s31 offen offset:0
    buffer_load_dwordx4 v[232:235], v255, s[12:15], s31 offen offset:64
    buffer_load_dwordx4 v[236:239], v255, s[12:15], s31 offen offset:128
    s_waitcnt vmcnt(0)
    v_mfma_f32_16x16x32_bf16 v[12:15], v[228:231], v[156:159], 0
    v_mfma_f32_16x16x32_bf16 v[16:19], v[228:231], v[180:183], 0
    v_mfma_f32_16x16x32_bf16 v[20:23], v[228:231], v[204:207], 0
    v_mfma_f32_16x16x32_bf16 v[12:15], v[232:235], v[160:163], v[12:15]
    v_mfma_f32_16x16x32_bf16 v[16:19], v[232:235], v[184:187], v[16:19]
    v_mfma_f32_16x16x32_bf16 v[20:23], v[232:235], v[208:211], v[20:23]
    v_mfma_f32_16x16x32_bf16 v[12:15], v[236:239], v[164:167], v[12:15]
    v_mfma_f32_16x16x32_bf16 v[16:19], v[236:239], v[188:191], v[16:19]
    v_mfma_f32_16x16x32_bf16 v[20:23], v[236:239], v[212:215], v[20:23]
    s_nop 7
    s_nop 7
    s_nop 7
    buffer_load_dwordx4 v[228:231], v255, s[12:15], s31 offen offset:192
    buffer_load_dwordx4 v[232:235], v255, s[12:15], s31 offen offset:256
    buffer_load_dwordx4 v[236:239], v255, s[12:15], s31 offen offset:320
    s_waitcnt vmcnt(0)
    v_mfma_f32_16x16x32_bf16 v[12:15], v[228:231], v[168:171], v[12:15]
    v_mfma_f32_16x16x32_bf16 v[16:19], v[228:231], v[192:195], v[16:19]
    v_mfma_f32_16x16x32_bf16 v[20:23], v[228:231], v[216:219], v[20:23]
    v_mfma_f32_16x16x32_bf16 v[12:15], v[232:235], v[172:175], v[12:15]
    v_mfma_f32_16x16x32_bf16 v[16:19], v[232:235], v[196:199], v[16:19]
    v_mfma_f32_16x16x32_bf16 v[20:23], v[232:235], v[220:223], v[20:23]
    v_mfma_f32_16x16x32_bf16 v[12:15], v[236:239], v[176:179], v[12:15]
    v_mfma_f32_16x16x32_bf16 v[16:19], v[236:239], v[200:203], v[16:19]
    v_mfma_f32_16x16x32_bf16 v[20:23], v[236:239], v[224:227], v[20:23]
    s_nop 7
    s_nop 7
    s_nop 7
    s_add_u32 s31, s31, 6144
    v_fma_f32 v12, v12, s29, -v245
    v_fma_f32 v13, v13, s29, -v245
    v_fma_f32 v14, v14, s29, -v245
    v_fma_f32 v15, v15, s29, -v245
    v_fma_f32 v16, v16, s29, -v247
    v_fma_f32 v17, v17, s29, -v247
    v_fma_f32 v18, v18, s29, -v247
    v_fma_f32 v19, v19, s29, -v247
    v_fma_f32 v20, v20, s29, -v249
    v_fma_f32 v21, v21, s29, -v249
    v_fma_f32 v22, v22, s29, -v249
    v_fma_f32 v23, v23, s29, -v249
    v_exp_f32 v12, v12
    v_exp_f32 v13, v13
    v_exp_f32 v14, v14
    v_exp_f32 v15, v15
    v_cvt_pk_bf16_f32 v12, v12, v13
    v_exp_f32 v16, v16
    v_exp_f32 v17, v17
    v_cvt_pk_bf16_f32 v13, v14, v15
    v_exp_f32 v18, v18
    v_exp_f32 v19, v19
    v_cvt_pk_bf16_f32 v16, v16, v17
    v_exp_f32 v20, v20
    v_exp_f32 v21, v21
    v_cvt_pk_bf16_f32 v17, v18, v19
    v_exp_f32 v22, v22
    v_exp_f32 v23, v23
    v_cvt_pk_bf16_f32 v20, v20, v21
    v_cvt_pk_bf16_f32 v21, v22, v23
    buffer_load_dwordx4 v[228:231], v255, s[12:15], s31 offen offset:0
    buffer_load_dwordx4 v[232:235], v255, s[12:15], s31 offen offset:64
    buffer_load_dwordx4 v[236:239], v255, s[12:15], s31 offen offset:128
    s_waitcnt vmcnt(0)
    v_mfma_f32_16x16x32_bf16 v[144:147], v[228:231], v[156:159], 0
    v_mfma_f32_16x16x32_bf16 v[148:151], v[228:231], v[180:183], 0
    v_mfma_f32_16x16x32_bf16 v[152:155], v[228:231], v[204:207], 0
    v_mfma_f32_16x16x32_bf16 v[144:147], v[232:235], v[160:163], v[144:147]
    v_mfma_f32_16x16x32_bf16 v[148:151], v[232:235], v[184:187], v[148:151]
    v_mfma_f32_16x16x32_bf16 v[152:155], v[232:235], v[208:211], v[152:155]
    v_mfma_f32_16x16x32_bf16 v[144:147], v[236:239], v[164:167], v[144:147]
    v_mfma_f32_16x16x32_bf16 v[148:151], v[236:239], v[188:191], v[148:151]
    v_mfma_f32_16x16x32_bf16 v[152:155], v[236:239], v[212:215], v[152:155]
    s_nop 7
    s_nop 7
    s_nop 7
    buffer_load_dwordx4 v[228:231], v255, s[12:15], s31 offen offset:192
    buffer_load_dwordx4 v[232:235], v255, s[12:15], s31 offen offset:256
    buffer_load_dwordx4 v[236:239], v255, s[12:15], s31 offen offset:320
    s_waitcnt vmcnt(0)
    v_mfma_f32_16x16x32_bf16 v[144:147], v[228:231], v[168:171], v[144:147]
    v_mfma_f32_16x16x32_bf16 v[148:151], v[228:231], v[192:195], v[148:151]
    v_mfma_f32_16x16x32_bf16 v[152:155], v[228:231], v[216:219], v[152:155]
    v_mfma_f32_16x16x32_bf16 v[144:147], v[232:235], v[172:175], v[144:147]
    v_mfma_f32_16x16x32_bf16 v[148:151], v[232:235], v[196:199], v[148:151]
    v_mfma_f32_16x16x32_bf16 v[152:155], v[232:235], v[220:223], v[152:155]
    v_mfma_f32_16x16x32_bf16 v[144:147], v[236:239], v[176:179], v[144:147]
    v_mfma_f32_16x16x32_bf16 v[148:151], v[236:239], v[200:203], v[148:151]
    v_mfma_f32_16x16x32_bf16 v[152:155], v[236:239], v[224:227], v[152:155]
    s_nop 7
    s_nop 7
    s_nop 7
    s_add_u32 s31, s31, 6144
    v_fma_f32 v144, v144, s29, -v245
    v_fma_f32 v145, v145, s29, -v245
    v_fma_f32 v146, v146, s29, -v245
    v_fma_f32 v147, v147, s29, -v245
    v_fma_f32 v148, v148, s29, -v247
    v_fma_f32 v149, v149, s29, -v247
    v_fma_f32 v150, v150, s29, -v247
    v_fma_f32 v151, v151, s29, -v247
    v_fma_f32 v152, v152, s29, -v249
    v_fma_f32 v153, v153, s29, -v249
    v_fma_f32 v154, v154, s29, -v249
    v_fma_f32 v155, v155, s29, -v249
    v_exp_f32 v144, v144
    v_exp_f32 v145, v145
    v_exp_f32 v146, v146
    v_exp_f32 v147, v147
    v_cvt_pk_bf16_f32 v14, v144, v145
    v_exp_f32 v148, v148
    v_exp_f32 v149, v149
    v_cvt_pk_bf16_f32 v15, v146, v147
    v_exp_f32 v150, v150
    v_exp_f32 v151, v151
    v_cvt_pk_bf16_f32 v18, v148, v149
    v_exp_f32 v152, v152
    v_exp_f32 v153, v153
    v_cvt_pk_bf16_f32 v19, v150, v151
    v_exp_f32 v154, v154
    v_exp_f32 v155, v155
    v_cvt_pk_bf16_f32 v22, v152, v153
    v_cvt_pk_bf16_f32 v23, v154, v155
    buffer_load_dwordx4 v[228:231], v255, s[12:15], s31 offen offset:0
    buffer_load_dwordx4 v[232:235], v255, s[12:15], s31 offen offset:64
    buffer_load_dwordx4 v[236:239], v255, s[12:15], s31 offen offset:128
    s_waitcnt vmcnt(0)
    v_mfma_f32_16x16x32_bf16 v[24:27], v[228:231], v[156:159], 0
    v_mfma_f32_16x16x32_bf16 v[28:31], v[228:231], v[180:183], 0
    v_mfma_f32_16x16x32_bf16 v[32:35], v[228:231], v[204:207], 0
    v_mfma_f32_16x16x32_bf16 v[24:27], v[232:235], v[160:163], v[24:27]
    v_mfma_f32_16x16x32_bf16 v[28:31], v[232:235], v[184:187], v[28:31]
    v_mfma_f32_16x16x32_bf16 v[32:35], v[232:235], v[208:211], v[32:35]
    v_mfma_f32_16x16x32_bf16 v[24:27], v[236:239], v[164:167], v[24:27]
    v_mfma_f32_16x16x32_bf16 v[28:31], v[236:239], v[188:191], v[28:31]
    v_mfma_f32_16x16x32_bf16 v[32:35], v[236:239], v[212:215], v[32:35]
    s_nop 7
    s_nop 7
    s_nop 7
    buffer_load_dwordx4 v[228:231], v255, s[12:15], s31 offen offset:192
    buffer_load_dwordx4 v[232:235], v255, s[12:15], s31 offen offset:256
    buffer_load_dwordx4 v[236:239], v255, s[12:15], s31 offen offset:320
    s_waitcnt vmcnt(0)
    v_mfma_f32_16x16x32_bf16 v[24:27], v[228:231], v[168:171], v[24:27]
    v_mfma_f32_16x16x32_bf16 v[28:31], v[228:231], v[192:195], v[28:31]
    v_mfma_f32_16x16x32_bf16 v[32:35], v[228:231], v[216:219], v[32:35]
    v_mfma_f32_16x16x32_bf16 v[24:27], v[232:235], v[172:175], v[24:27]
    v_mfma_f32_16x16x32_bf16 v[28:31], v[232:235], v[196:199], v[28:31]
    v_mfma_f32_16x16x32_bf16 v[32:35], v[232:235], v[220:223], v[32:35]
    v_mfma_f32_16x16x32_bf16 v[24:27], v[236:239], v[176:179], v[24:27]
    v_mfma_f32_16x16x32_bf16 v[28:31], v[236:239], v[200:203], v[28:31]
    v_mfma_f32_16x16x32_bf16 v[32:35], v[236:239], v[224:227], v[32:35]
    s_nop 7
    s_nop 7
    s_nop 7
    s_add_u32 s31, s31, 6144
    v_fma_f32 v24, v24, s29, -v245
    v_fma_f32 v25, v25, s29, -v245
    v_fma_f32 v26, v26, s29, -v245
    v_fma_f32 v27, v27, s29, -v245
    v_fma_f32 v28, v28, s29, -v247
    v_fma_f32 v29, v29, s29, -v247
    v_fma_f32 v30, v30, s29, -v247
    v_fma_f32 v31, v31, s29, -v247
    v_fma_f32 v32, v32, s29, -v249
    v_fma_f32 v33, v33, s29, -v249
    v_fma_f32 v34, v34, s29, -v249
    v_fma_f32 v35, v35, s29, -v249
    v_exp_f32 v24, v24
    v_exp_f32 v25, v25
    v_exp_f32 v26, v26
    v_exp_f32 v27, v27
    v_cvt_pk_bf16_f32 v24, v24, v25
    v_exp_f32 v28, v28
    v_exp_f32 v29, v29
    v_cvt_pk_bf16_f32 v25, v26, v27
    v_exp_f32 v30, v30
    v_exp_f32 v31, v31
    v_cvt_pk_bf16_f32 v28, v28, v29
    v_exp_f32 v32, v32
    v_exp_f32 v33, v33
    v_cvt_pk_bf16_f32 v29, v30, v31
    v_exp_f32 v34, v34
    v_exp_f32 v35, v35
    v_cvt_pk_bf16_f32 v32, v32, v33
    v_cvt_pk_bf16_f32 v33, v34, v35
    buffer_load_dwordx4 v[228:231], v255, s[12:15], s31 offen offset:0
    buffer_load_dwordx4 v[232:235], v255, s[12:15], s31 offen offset:64
    buffer_load_dwordx4 v[236:239], v255, s[12:15], s31 offen offset:128
    s_waitcnt vmcnt(0)
    v_mfma_f32_16x16x32_bf16 v[144:147], v[228:231], v[156:159], 0
    v_mfma_f32_16x16x32_bf16 v[148:151], v[228:231], v[180:183], 0
    v_mfma_f32_16x16x32_bf16 v[152:155], v[228:231], v[204:207], 0
    v_mfma_f32_16x16x32_bf16 v[144:147], v[232:235], v[160:163], v[144:147]
    v_mfma_f32_16x16x32_bf16 v[148:151], v[232:235], v[184:187], v[148:151]
    v_mfma_f32_16x16x32_bf16 v[152:155], v[232:235], v[208:211], v[152:155]
    v_mfma_f32_16x16x32_bf16 v[144:147], v[236:239], v[164:167], v[144:147]
    v_mfma_f32_16x16x32_bf16 v[148:151], v[236:239], v[188:191], v[148:151]
    v_mfma_f32_16x16x32_bf16 v[152:155], v[236:239], v[212:215], v[152:155]
    s_nop 7
    s_nop 7
    s_nop 7
    buffer_load_dwordx4 v[228:231], v255, s[12:15], s31 offen offset:192
    buffer_load_dwordx4 v[232:235], v255, s[12:15], s31 offen offset:256
    buffer_load_dwordx4 v[236:239], v255, s[12:15], s31 offen offset:320
    s_waitcnt vmcnt(0)
    v_mfma_f32_16x16x32_bf16 v[144:147], v[228:231], v[168:171], v[144:147]
    v_mfma_f32_16x16x32_bf16 v[148:151], v[228:231], v[192:195], v[148:151]
    v_mfma_f32_16x16x32_bf16 v[152:155], v[228:231], v[216:219], v[152:155]
    v_mfma_f32_16x16x32_bf16 v[144:147], v[232:235], v[172:175], v[144:147]
    v_mfma_f32_16x16x32_bf16 v[148:151], v[232:235], v[196:199], v[148:151]
    v_mfma_f32_16x16x32_bf16 v[152:155], v[232:235], v[220:223], v[152:155]
    v_mfma_f32_16x16x32_bf16 v[144:147], v[236:239], v[176:179], v[144:147]
    v_mfma_f32_16x16x32_bf16 v[148:151], v[236:239], v[200:203], v[148:151]
    v_mfma_f32_16x16x32_bf16 v[152:155], v[236:239], v[224:227], v[152:155]
    s_nop 7
    s_nop 7
    s_nop 7
    s_add_u32 s31, s31, 6144
    v_fma_f32 v144, v144, s29, -v245
    v_fma_f32 v145, v145, s29, -v245
    v_fma_f32 v146, v146, s29, -v245
    v_fma_f32 v147, v147, s29, -v245
    v_fma_f32 v148, v148, s29, -v247
    v_fma_f32 v149, v149, s29, -v247
    v_fma_f32 v150, v150, s29, -v247
    v_fma_f32 v151, v151, s29, -v247
    v_fma_f32 v152, v152, s29, -v249
    v_fma_f32 v153, v153, s29, -v249
    v_fma_f32 v154, v154, s29, -v249
    v_fma_f32 v155, v155, s29, -v249
    v_exp_f32 v144, v144
    v_exp_f32 v145, v145
    v_exp_f32 v146, v146
    v_exp_f32 v147, v147
    v_cvt_pk_bf16_f32 v26, v144, v145
    v_exp_f32 v148, v148
    v_exp_f32 v149, v149
    v_cvt_pk_bf16_f32 v27, v146, v147
    v_exp_f32 v150, v150
    v_exp_f32 v151, v151
    v_cvt_pk_bf16_f32 v30, v148, v149
    v_exp_f32 v152, v152
    v_exp_f32 v153, v153
    v_cvt_pk_bf16_f32 v31, v150, v151
    v_exp_f32 v154, v154
    v_exp_f32 v155, v155
    v_cvt_pk_bf16_f32 v34, v152, v153
    v_cvt_pk_bf16_f32 v35, v154, v155
    buffer_load_dwordx4 v[228:231], v255, s[12:15], s31 offen offset:0
    buffer_load_dwordx4 v[232:235], v255, s[12:15], s31 offen offset:64
    buffer_load_dwordx4 v[236:239], v255, s[12:15], s31 offen offset:128
    s_waitcnt vmcnt(0)
    v_mfma_f32_16x16x32_bf16 v[36:39], v[228:231], v[156:159], 0
    v_mfma_f32_16x16x32_bf16 v[40:43], v[228:231], v[180:183], 0
    v_mfma_f32_16x16x32_bf16 v[44:47], v[228:231], v[204:207], 0
    v_mfma_f32_16x16x32_bf16 v[36:39], v[232:235], v[160:163], v[36:39]
    v_mfma_f32_16x16x32_bf16 v[40:43], v[232:235], v[184:187], v[40:43]
    v_mfma_f32_16x16x32_bf16 v[44:47], v[232:235], v[208:211], v[44:47]
    v_mfma_f32_16x16x32_bf16 v[36:39], v[236:239], v[164:167], v[36:39]
    v_mfma_f32_16x16x32_bf16 v[40:43], v[236:239], v[188:191], v[40:43]
    v_mfma_f32_16x16x32_bf16 v[44:47], v[236:239], v[212:215], v[44:47]
    s_nop 7
    s_nop 7
    s_nop 7
    buffer_load_dwordx4 v[228:231], v255, s[12:15], s31 offen offset:192
    buffer_load_dwordx4 v[232:235], v255, s[12:15], s31 offen offset:256
    buffer_load_dwordx4 v[236:239], v255, s[12:15], s31 offen offset:320
    s_waitcnt vmcnt(0)
    v_mfma_f32_16x16x32_bf16 v[36:39], v[228:231], v[168:171], v[36:39]
    v_mfma_f32_16x16x32_bf16 v[40:43], v[228:231], v[192:195], v[40:43]
    v_mfma_f32_16x16x32_bf16 v[44:47], v[228:231], v[216:219], v[44:47]
    v_mfma_f32_16x16x32_bf16 v[36:39], v[232:235], v[172:175], v[36:39]
    v_mfma_f32_16x16x32_bf16 v[40:43], v[232:235], v[196:199], v[40:43]
    v_mfma_f32_16x16x32_bf16 v[44:47], v[232:235], v[220:223], v[44:47]
    v_mfma_f32_16x16x32_bf16 v[36:39], v[236:239], v[176:179], v[36:39]
    v_mfma_f32_16x16x32_bf16 v[40:43], v[236:239], v[200:203], v[40:43]
    v_mfma_f32_16x16x32_bf16 v[44:47], v[236:239], v[224:227], v[44:47]
    s_nop 7
    s_nop 7
    s_nop 7
    s_add_u32 s31, s31, 6144
    v_fma_f32 v36, v36, s29, -v245
    v_fma_f32 v37, v37, s29, -v245
    v_fma_f32 v38, v38, s29, -v245
    v_fma_f32 v39, v39, s29, -v245
    v_fma_f32 v40, v40, s29, -v247
    v_fma_f32 v41, v41, s29, -v247
    v_fma_f32 v42, v42, s29, -v247
    v_fma_f32 v43, v43, s29, -v247
    v_fma_f32 v44, v44, s29, -v249
    v_fma_f32 v45, v45, s29, -v249
    v_fma_f32 v46, v46, s29, -v249
    v_fma_f32 v47, v47, s29, -v249
    v_exp_f32 v36, v36
    v_exp_f32 v37, v37
    v_exp_f32 v38, v38
    v_exp_f32 v39, v39
    v_cvt_pk_bf16_f32 v36, v36, v37
    v_exp_f32 v40, v40
    v_exp_f32 v41, v41
    v_cvt_pk_bf16_f32 v37, v38, v39
    v_exp_f32 v42, v42
    v_exp_f32 v43, v43
    v_cvt_pk_bf16_f32 v40, v40, v41
    v_exp_f32 v44, v44
    v_exp_f32 v45, v45
    v_cvt_pk_bf16_f32 v41, v42, v43
    v_exp_f32 v46, v46
    v_exp_f32 v47, v47
    v_cvt_pk_bf16_f32 v44, v44, v45
    v_cvt_pk_bf16_f32 v45, v46, v47
    buffer_load_dwordx4 v[228:231], v255, s[12:15], s31 offen offset:0
    buffer_load_dwordx4 v[232:235], v255, s[12:15], s31 offen offset:64
    buffer_load_dwordx4 v[236:239], v255, s[12:15], s31 offen offset:128
    s_waitcnt vmcnt(0)
    v_mfma_f32_16x16x32_bf16 v[144:147], v[228:231], v[156:159], 0
    v_mfma_f32_16x16x32_bf16 v[148:151], v[228:231], v[180:183], 0
    v_mfma_f32_16x16x32_bf16 v[152:155], v[228:231], v[204:207], 0
    v_mfma_f32_16x16x32_bf16 v[144:147], v[232:235], v[160:163], v[144:147]
    v_mfma_f32_16x16x32_bf16 v[148:151], v[232:235], v[184:187], v[148:151]
    v_mfma_f32_16x16x32_bf16 v[152:155], v[232:235], v[208:211], v[152:155]
    v_mfma_f32_16x16x32_bf16 v[144:147], v[236:239], v[164:167], v[144:147]
    v_mfma_f32_16x16x32_bf16 v[148:151], v[236:239], v[188:191], v[148:151]
    v_mfma_f32_16x16x32_bf16 v[152:155], v[236:239], v[212:215], v[152:155]
    s_nop 7
    s_nop 7
    s_nop 7
    buffer_load_dwordx4 v[228:231], v255, s[12:15], s31 offen offset:192
    buffer_load_dwordx4 v[232:235], v255, s[12:15], s31 offen offset:256
    buffer_load_dwordx4 v[236:239], v255, s[12:15], s31 offen offset:320
    s_waitcnt vmcnt(0)
    v_mfma_f32_16x16x32_bf16 v[144:147], v[228:231], v[168:171], v[144:147]
    v_mfma_f32_16x16x32_bf16 v[148:151], v[228:231], v[192:195], v[148:151]
    v_mfma_f32_16x16x32_bf16 v[152:155], v[228:231], v[216:219], v[152:155]
    v_mfma_f32_16x16x32_bf16 v[144:147], v[232:235], v[172:175], v[144:147]
    v_mfma_f32_16x16x32_bf16 v[148:151], v[232:235], v[196:199], v[148:151]
    v_mfma_f32_16x16x32_bf16 v[152:155], v[232:235], v[220:223], v[152:155]
    v_mfma_f32_16x16x32_bf16 v[144:147], v[236:239], v[176:179], v[144:147]
    v_mfma_f32_16x16x32_bf16 v[148:151], v[236:239], v[200:203], v[148:151]
    v_mfma_f32_16x16x32_bf16 v[152:155], v[236:239], v[224:227], v[152:155]
    s_nop 7
    s_nop 7
    s_nop 7
    s_add_u32 s31, s31, 6144
    v_fma_f32 v144, v144, s29, -v245
    v_fma_f32 v145, v145, s29, -v245
    v_fma_f32 v146, v146, s29, -v245
    v_fma_f32 v147, v147, s29, -v245
    v_fma_f32 v148, v148, s29, -v247
    v_fma_f32 v149, v149, s29, -v247
    v_fma_f32 v150, v150, s29, -v247
    v_fma_f32 v151, v151, s29, -v247
    v_fma_f32 v152, v152, s29, -v249
    v_fma_f32 v153, v153, s29, -v249
    v_fma_f32 v154, v154, s29, -v249
    v_fma_f32 v155, v155, s29, -v249
    v_exp_f32 v144, v144
    v_exp_f32 v145, v145
    v_exp_f32 v146, v146
    v_exp_f32 v147, v147
    v_cvt_pk_bf16_f32 v38, v144, v145
    v_exp_f32 v148, v148
    v_exp_f32 v149, v149
    v_cvt_pk_bf16_f32 v39, v146, v147
    v_exp_f32 v150, v150
    v_exp_f32 v151, v151
    v_cvt_pk_bf16_f32 v42, v148, v149
    v_exp_f32 v152, v152
    v_exp_f32 v153, v153
    v_cvt_pk_bf16_f32 v43, v150, v151
    v_exp_f32 v154, v154
    v_exp_f32 v155, v155
    v_cvt_pk_bf16_f32 v46, v152, v153
    v_cvt_pk_bf16_f32 v47, v154, v155
    buffer_load_dwordx4 v[228:231], v255, s[12:15], s31 offen offset:0
    buffer_load_dwordx4 v[232:235], v255, s[12:15], s31 offen offset:64
    buffer_load_dwordx4 v[236:239], v255, s[12:15], s31 offen offset:128
    s_waitcnt vmcnt(0)
    v_mfma_f32_16x16x32_bf16 v[48:51], v[228:231], v[156:159], 0
    v_mfma_f32_16x16x32_bf16 v[52:55], v[228:231], v[180:183], 0
    v_mfma_f32_16x16x32_bf16 v[56:59], v[228:231], v[204:207], 0
    v_mfma_f32_16x16x32_bf16 v[48:51], v[232:235], v[160:163], v[48:51]
    v_mfma_f32_16x16x32_bf16 v[52:55], v[232:235], v[184:187], v[52:55]
    v_mfma_f32_16x16x32_bf16 v[56:59], v[232:235], v[208:211], v[56:59]
    v_mfma_f32_16x16x32_bf16 v[48:51], v[236:239], v[164:167], v[48:51]
    v_mfma_f32_16x16x32_bf16 v[52:55], v[236:239], v[188:191], v[52:55]
    v_mfma_f32_16x16x32_bf16 v[56:59], v[236:239], v[212:215], v[56:59]
    s_nop 7
    s_nop 7
    s_nop 7
    buffer_load_dwordx4 v[228:231], v255, s[12:15], s31 offen offset:192
    buffer_load_dwordx4 v[232:235], v255, s[12:15], s31 offen offset:256
    buffer_load_dwordx4 v[236:239], v255, s[12:15], s31 offen offset:320
    s_waitcnt vmcnt(0)
    v_mfma_f32_16x16x32_bf16 v[48:51], v[228:231], v[168:171], v[48:51]
    v_mfma_f32_16x16x32_bf16 v[52:55], v[228:231], v[192:195], v[52:55]
    v_mfma_f32_16x16x32_bf16 v[56:59], v[228:231], v[216:219], v[56:59]
    v_mfma_f32_16x16x32_bf16 v[48:51], v[232:235], v[172:175], v[48:51]
    v_mfma_f32_16x16x32_bf16 v[52:55], v[232:235], v[196:199], v[52:55]
    v_mfma_f32_16x16x32_bf16 v[56:59], v[232:235], v[220:223], v[56:59]
    v_mfma_f32_16x16x32_bf16 v[48:51], v[236:239], v[176:179], v[48:51]
    v_mfma_f32_16x16x32_bf16 v[52:55], v[236:239], v[200:203], v[52:55]
    v_mfma_f32_16x16x32_bf16 v[56:59], v[236:239], v[224:227], v[56:59]
    s_nop 7
    s_nop 7
    s_nop 7
    s_add_u32 s31, s31, 6144
    v_fma_f32 v48, v48, s29, -v245
    v_fma_f32 v49, v49, s29, -v245
    v_fma_f32 v50, v50, s29, -v245
    v_fma_f32 v51, v51, s29, -v245
    v_fma_f32 v52, v52, s29, -v247
    v_fma_f32 v53, v53, s29, -v247
    v_fma_f32 v54, v54, s29, -v247
    v_fma_f32 v55, v55, s29, -v247
    v_fma_f32 v56, v56, s29, -v249
    v_fma_f32 v57, v57, s29, -v249
    v_fma_f32 v58, v58, s29, -v249
    v_fma_f32 v59, v59, s29, -v249
    v_exp_f32 v48, v48
    v_exp_f32 v49, v49
    v_exp_f32 v50, v50
    v_exp_f32 v51, v51
    v_cvt_pk_bf16_f32 v48, v48, v49
    v_exp_f32 v52, v52
    v_exp_f32 v53, v53
    v_cvt_pk_bf16_f32 v49, v50, v51
    v_exp_f32 v54, v54
    v_exp_f32 v55, v55
    v_cvt_pk_bf16_f32 v52, v52, v53
    v_exp_f32 v56, v56
    v_exp_f32 v57, v57
    v_cvt_pk_bf16_f32 v53, v54, v55
    v_exp_f32 v58, v58
    v_exp_f32 v59, v59
    v_cvt_pk_bf16_f32 v56, v56, v57
    v_cvt_pk_bf16_f32 v57, v58, v59
    buffer_load_dwordx4 v[228:231], v255, s[12:15], s31 offen offset:0
    buffer_load_dwordx4 v[232:235], v255, s[12:15], s31 offen offset:64
    buffer_load_dwordx4 v[236:239], v255, s[12:15], s31 offen offset:128
    s_waitcnt vmcnt(0)
    v_mfma_f32_16x16x32_bf16 v[144:147], v[228:231], v[156:159], 0
    v_mfma_f32_16x16x32_bf16 v[148:151], v[228:231], v[180:183], 0
    v_mfma_f32_16x16x32_bf16 v[152:155], v[228:231], v[204:207], 0
    v_mfma_f32_16x16x32_bf16 v[144:147], v[232:235], v[160:163], v[144:147]
    v_mfma_f32_16x16x32_bf16 v[148:151], v[232:235], v[184:187], v[148:151]
    v_mfma_f32_16x16x32_bf16 v[152:155], v[232:235], v[208:211], v[152:155]
    v_mfma_f32_16x16x32_bf16 v[144:147], v[236:239], v[164:167], v[144:147]
    v_mfma_f32_16x16x32_bf16 v[148:151], v[236:239], v[188:191], v[148:151]
    v_mfma_f32_16x16x32_bf16 v[152:155], v[236:239], v[212:215], v[152:155]
    s_nop 7
    s_nop 7
    s_nop 7
    buffer_load_dwordx4 v[228:231], v255, s[12:15], s31 offen offset:192
    buffer_load_dwordx4 v[232:235], v255, s[12:15], s31 offen offset:256
    buffer_load_dwordx4 v[236:239], v255, s[12:15], s31 offen offset:320
    s_waitcnt vmcnt(0)
    v_mfma_f32_16x16x32_bf16 v[144:147], v[228:231], v[168:171], v[144:147]
    v_mfma_f32_16x16x32_bf16 v[148:151], v[228:231], v[192:195], v[148:151]
    v_mfma_f32_16x16x32_bf16 v[152:155], v[228:231], v[216:219], v[152:155]
    v_mfma_f32_16x16x32_bf16 v[144:147], v[232:235], v[172:175], v[144:147]
    v_mfma_f32_16x16x32_bf16 v[148:151], v[232:235], v[196:199], v[148:151]
    v_mfma_f32_16x16x32_bf16 v[152:155], v[232:235], v[220:223], v[152:155]
    v_mfma_f32_16x16x32_bf16 v[144:147], v[236:239], v[176:179], v[144:147]
    v_mfma_f32_16x16x32_bf16 v[148:151], v[236:239], v[200:203], v[148:151]
    v_mfma_f32_16x16x32_bf16 v[152:155], v[236:239], v[224:227], v[152:155]
    s_nop 7
    s_nop 7
    s_nop 7
    s_add_u32 s31, s31, 6144
    v_fma_f32 v144, v144, s29, -v245
    v_fma_f32 v145, v145, s29, -v245
    v_fma_f32 v146, v146, s29, -v245
    v_fma_f32 v147, v147, s29, -v245
    v_fma_f32 v148, v148, s29, -v247
    v_fma_f32 v149, v149, s29, -v247
    v_fma_f32 v150, v150, s29, -v247
    v_fma_f32 v151, v151, s29, -v247
    v_fma_f32 v152, v152, s29, -v249
    v_fma_f32 v153, v153, s29, -v249
    v_fma_f32 v154, v154, s29, -v249
    v_fma_f32 v155, v155, s29, -v249
    v_exp_f32 v144, v144
    v_exp_f32 v145, v145
    v_exp_f32 v146, v146
    v_exp_f32 v147, v147
    v_cvt_pk_bf16_f32 v50, v144, v145
    v_exp_f32 v148, v148
    v_exp_f32 v149, v149
    v_cvt_pk_bf16_f32 v51, v146, v147
    v_exp_f32 v150, v150
    v_exp_f32 v151, v151
    v_cvt_pk_bf16_f32 v54, v148, v149
    v_exp_f32 v152, v152
    v_exp_f32 v153, v153
    v_cvt_pk_bf16_f32 v55, v150, v151
    v_exp_f32 v154, v154
    v_exp_f32 v155, v155
    v_cvt_pk_bf16_f32 v58, v152, v153
    v_cvt_pk_bf16_f32 v59, v154, v155
    buffer_load_dwordx4 v[228:231], v255, s[12:15], s31 offen offset:0
    buffer_load_dwordx4 v[232:235], v255, s[12:15], s31 offen offset:64
    buffer_load_dwordx4 v[236:239], v255, s[12:15], s31 offen offset:128
    s_waitcnt vmcnt(0)
    v_mfma_f32_16x16x32_bf16 v[60:63], v[228:231], v[156:159], 0
    v_mfma_f32_16x16x32_bf16 v[64:67], v[228:231], v[180:183], 0
    v_mfma_f32_16x16x32_bf16 v[68:71], v[228:231], v[204:207], 0
    v_mfma_f32_16x16x32_bf16 v[60:63], v[232:235], v[160:163], v[60:63]
    v_mfma_f32_16x16x32_bf16 v[64:67], v[232:235], v[184:187], v[64:67]
    v_mfma_f32_16x16x32_bf16 v[68:71], v[232:235], v[208:211], v[68:71]
    v_mfma_f32_16x16x32_bf16 v[60:63], v[236:239], v[164:167], v[60:63]
    v_mfma_f32_16x16x32_bf16 v[64:67], v[236:239], v[188:191], v[64:67]
    v_mfma_f32_16x16x32_bf16 v[68:71], v[236:239], v[212:215], v[68:71]
    s_nop 7
    s_nop 7
    s_nop 7
    buffer_load_dwordx4 v[228:231], v255, s[12:15], s31 offen offset:192
    buffer_load_dwordx4 v[232:235], v255, s[12:15], s31 offen offset:256
    buffer_load_dwordx4 v[236:239], v255, s[12:15], s31 offen offset:320
    s_waitcnt vmcnt(0)
    v_mfma_f32_16x16x32_bf16 v[60:63], v[228:231], v[168:171], v[60:63]
    v_mfma_f32_16x16x32_bf16 v[64:67], v[228:231], v[192:195], v[64:67]
    v_mfma_f32_16x16x32_bf16 v[68:71], v[228:231], v[216:219], v[68:71]
    v_mfma_f32_16x16x32_bf16 v[60:63], v[232:235], v[172:175], v[60:63]
    v_mfma_f32_16x16x32_bf16 v[64:67], v[232:235], v[196:199], v[64:67]
    v_mfma_f32_16x16x32_bf16 v[68:71], v[232:235], v[220:223], v[68:71]
    v_mfma_f32_16x16x32_bf16 v[60:63], v[236:239], v[176:179], v[60:63]
    v_mfma_f32_16x16x32_bf16 v[64:67], v[236:239], v[200:203], v[64:67]
    v_mfma_f32_16x16x32_bf16 v[68:71], v[236:239], v[224:227], v[68:71]
    s_nop 7
    s_nop 7
    s_nop 7
    s_add_u32 s31, s31, 6144
    v_fma_f32 v60, v60, s29, -v245
    v_fma_f32 v61, v61, s29, -v245
    v_fma_f32 v62, v62, s29, -v245
    v_fma_f32 v63, v63, s29, -v245
    v_fma_f32 v64, v64, s29, -v247
    v_fma_f32 v65, v65, s29, -v247
    v_fma_f32 v66, v66, s29, -v247
    v_fma_f32 v67, v67, s29, -v247
    v_fma_f32 v68, v68, s29, -v249
    v_fma_f32 v69, v69, s29, -v249
    v_fma_f32 v70, v70, s29, -v249
    v_fma_f32 v71, v71, s29, -v249
    v_exp_f32 v60, v60
    v_exp_f32 v61, v61
    v_exp_f32 v62, v62
    v_exp_f32 v63, v63
    v_cvt_pk_bf16_f32 v60, v60, v61
    v_exp_f32 v64, v64
    v_exp_f32 v65, v65
    v_cvt_pk_bf16_f32 v61, v62, v63
    v_exp_f32 v66, v66
    v_exp_f32 v67, v67
    v_cvt_pk_bf16_f32 v64, v64, v65
    v_exp_f32 v68, v68
    v_exp_f32 v69, v69
    v_cvt_pk_bf16_f32 v65, v66, v67
    v_exp_f32 v70, v70
    v_exp_f32 v71, v71
    v_cvt_pk_bf16_f32 v68, v68, v69
    v_cvt_pk_bf16_f32 v69, v70, v71
    buffer_load_dwordx4 v[228:231], v255, s[12:15], s31 offen offset:0
    buffer_load_dwordx4 v[232:235], v255, s[12:15], s31 offen offset:64
    buffer_load_dwordx4 v[236:239], v255, s[12:15], s31 offen offset:128
    s_waitcnt vmcnt(0)
    v_mfma_f32_16x16x32_bf16 v[144:147], v[228:231], v[156:159], 0
    v_mfma_f32_16x16x32_bf16 v[148:151], v[228:231], v[180:183], 0
    v_mfma_f32_16x16x32_bf16 v[152:155], v[228:231], v[204:207], 0
    v_mfma_f32_16x16x32_bf16 v[144:147], v[232:235], v[160:163], v[144:147]
    v_mfma_f32_16x16x32_bf16 v[148:151], v[232:235], v[184:187], v[148:151]
    v_mfma_f32_16x16x32_bf16 v[152:155], v[232:235], v[208:211], v[152:155]
    v_mfma_f32_16x16x32_bf16 v[144:147], v[236:239], v[164:167], v[144:147]
    v_mfma_f32_16x16x32_bf16 v[148:151], v[236:239], v[188:191], v[148:151]
    v_mfma_f32_16x16x32_bf16 v[152:155], v[236:239], v[212:215], v[152:155]
    s_nop 7
    s_nop 7
    s_nop 7
    buffer_load_dwordx4 v[228:231], v255, s[12:15], s31 offen offset:192
    buffer_load_dwordx4 v[232:235], v255, s[12:15], s31 offen offset:256
    buffer_load_dwordx4 v[236:239], v255, s[12:15], s31 offen offset:320
    s_waitcnt vmcnt(0)
    v_mfma_f32_16x16x32_bf16 v[144:147], v[228:231], v[168:171], v[144:147]
    v_mfma_f32_16x16x32_bf16 v[148:151], v[228:231], v[192:195], v[148:151]
    v_mfma_f32_16x16x32_bf16 v[152:155], v[228:231], v[216:219], v[152:155]
    v_mfma_f32_16x16x32_bf16 v[144:147], v[232:235], v[172:175], v[144:147]
    v_mfma_f32_16x16x32_bf16 v[148:151], v[232:235], v[196:199], v[148:151]
    v_mfma_f32_16x16x32_bf16 v[152:155], v[232:235], v[220:223], v[152:155]
    v_mfma_f32_16x16x32_bf16 v[144:147], v[236:239], v[176:179], v[144:147]
    v_mfma_f32_16x16x32_bf16 v[148:151], v[236:239], v[200:203], v[148:151]
    v_mfma_f32_16x16x32_bf16 v[152:155], v[236:239], v[224:227], v[152:155]
    s_nop 7
    s_nop 7
    s_nop 7
    s_add_u32 s31, s31, 6144
    v_fma_f32 v144, v144, s29, -v245
    v_fma_f32 v145, v145, s29, -v245
    v_fma_f32 v146, v146, s29, -v245
    v_fma_f32 v147, v147, s29, -v245
    v_fma_f32 v148, v148, s29, -v247
    v_fma_f32 v149, v149, s29, -v247
    v_fma_f32 v150, v150, s29, -v247
    v_fma_f32 v151, v151, s29, -v247
    v_fma_f32 v152, v152, s29, -v249
    v_fma_f32 v153, v153, s29, -v249
    v_fma_f32 v154, v154, s29, -v249
    v_fma_f32 v155, v155, s29, -v249
    v_exp_f32 v144, v144
    v_exp_f32 v145, v145
    v_exp_f32 v146, v146
    v_exp_f32 v147, v147
    v_cvt_pk_bf16_f32 v62, v144, v145
    v_exp_f32 v148, v148
    v_exp_f32 v149, v149
    v_cvt_pk_bf16_f32 v63, v146, v147
    v_exp_f32 v150, v150
    v_exp_f32 v151, v151
    v_cvt_pk_bf16_f32 v66, v148, v149
    v_exp_f32 v152, v152
    v_exp_f32 v153, v153
    v_cvt_pk_bf16_f32 v67, v150, v151
    v_exp_f32 v154, v154
    v_exp_f32 v155, v155
    v_cvt_pk_bf16_f32 v70, v152, v153
    v_cvt_pk_bf16_f32 v71, v154, v155
    buffer_load_dwordx4 v[228:231], v255, s[12:15], s31 offen offset:0
    buffer_load_dwordx4 v[232:235], v255, s[12:15], s31 offen offset:64
    buffer_load_dwordx4 v[236:239], v255, s[12:15], s31 offen offset:128
    s_waitcnt vmcnt(0)
    v_mfma_f32_16x16x32_bf16 v[72:75], v[228:231], v[156:159], 0
    v_mfma_f32_16x16x32_bf16 v[76:79], v[228:231], v[180:183], 0
    v_mfma_f32_16x16x32_bf16 v[80:83], v[228:231], v[204:207], 0
    v_mfma_f32_16x16x32_bf16 v[72:75], v[232:235], v[160:163], v[72:75]
    v_mfma_f32_16x16x32_bf16 v[76:79], v[232:235], v[184:187], v[76:79]
    v_mfma_f32_16x16x32_bf16 v[80:83], v[232:235], v[208:211], v[80:83]
    v_mfma_f32_16x16x32_bf16 v[72:75], v[236:239], v[164:167], v[72:75]
    v_mfma_f32_16x16x32_bf16 v[76:79], v[236:239], v[188:191], v[76:79]
    v_mfma_f32_16x16x32_bf16 v[80:83], v[236:239], v[212:215], v[80:83]
    s_nop 7
    s_nop 7
    s_nop 7
    buffer_load_dwordx4 v[228:231], v255, s[12:15], s31 offen offset:192
    buffer_load_dwordx4 v[232:235], v255, s[12:15], s31 offen offset:256
    buffer_load_dwordx4 v[236:239], v255, s[12:15], s31 offen offset:320
    s_waitcnt vmcnt(0)
    v_mfma_f32_16x16x32_bf16 v[72:75], v[228:231], v[168:171], v[72:75]
    v_mfma_f32_16x16x32_bf16 v[76:79], v[228:231], v[192:195], v[76:79]
    v_mfma_f32_16x16x32_bf16 v[80:83], v[228:231], v[216:219], v[80:83]
    v_mfma_f32_16x16x32_bf16 v[72:75], v[232:235], v[172:175], v[72:75]
    v_mfma_f32_16x16x32_bf16 v[76:79], v[232:235], v[196:199], v[76:79]
    v_mfma_f32_16x16x32_bf16 v[80:83], v[232:235], v[220:223], v[80:83]
    v_mfma_f32_16x16x32_bf16 v[72:75], v[236:239], v[176:179], v[72:75]
    v_mfma_f32_16x16x32_bf16 v[76:79], v[236:239], v[200:203], v[76:79]
    v_mfma_f32_16x16x32_bf16 v[80:83], v[236:239], v[224:227], v[80:83]
    s_nop 7
    s_nop 7
    s_nop 7
    s_add_u32 s31, s31, 6144
    v_fma_f32 v72, v72, s29, -v245
    v_fma_f32 v73, v73, s29, -v245
    v_fma_f32 v74, v74, s29, -v245
    v_fma_f32 v75, v75, s29, -v245
    v_fma_f32 v76, v76, s29, -v247
    v_fma_f32 v77, v77, s29, -v247
    v_fma_f32 v78, v78, s29, -v247
    v_fma_f32 v79, v79, s29, -v247
    v_fma_f32 v80, v80, s29, -v249
    v_fma_f32 v81, v81, s29, -v249
    v_fma_f32 v82, v82, s29, -v249
    v_fma_f32 v83, v83, s29, -v249
    v_exp_f32 v72, v72
    v_exp_f32 v73, v73
    v_exp_f32 v74, v74
    v_exp_f32 v75, v75
    v_cvt_pk_bf16_f32 v72, v72, v73
    v_exp_f32 v76, v76
    v_exp_f32 v77, v77
    v_cvt_pk_bf16_f32 v73, v74, v75
    v_exp_f32 v78, v78
    v_exp_f32 v79, v79
    v_cvt_pk_bf16_f32 v76, v76, v77
    v_exp_f32 v80, v80
    v_exp_f32 v81, v81
    v_cvt_pk_bf16_f32 v77, v78, v79
    v_exp_f32 v82, v82
    v_exp_f32 v83, v83
    v_cvt_pk_bf16_f32 v80, v80, v81
    v_cvt_pk_bf16_f32 v81, v82, v83
    buffer_load_dwordx4 v[228:231], v255, s[12:15], s31 offen offset:0
    buffer_load_dwordx4 v[232:235], v255, s[12:15], s31 offen offset:64
    buffer_load_dwordx4 v[236:239], v255, s[12:15], s31 offen offset:128
    s_waitcnt vmcnt(0)
    v_mfma_f32_16x16x32_bf16 v[144:147], v[228:231], v[156:159], 0
    v_mfma_f32_16x16x32_bf16 v[148:151], v[228:231], v[180:183], 0
    v_mfma_f32_16x16x32_bf16 v[152:155], v[228:231], v[204:207], 0
    v_mfma_f32_16x16x32_bf16 v[144:147], v[232:235], v[160:163], v[144:147]
    v_mfma_f32_16x16x32_bf16 v[148:151], v[232:235], v[184:187], v[148:151]
    v_mfma_f32_16x16x32_bf16 v[152:155], v[232:235], v[208:211], v[152:155]
    v_mfma_f32_16x16x32_bf16 v[144:147], v[236:239], v[164:167], v[144:147]
    v_mfma_f32_16x16x32_bf16 v[148:151], v[236:239], v[188:191], v[148:151]
    v_mfma_f32_16x16x32_bf16 v[152:155], v[236:239], v[212:215], v[152:155]
    s_nop 7
    s_nop 7
    s_nop 7
    buffer_load_dwordx4 v[228:231], v255, s[12:15], s31 offen offset:192
    buffer_load_dwordx4 v[232:235], v255, s[12:15], s31 offen offset:256
    buffer_load_dwordx4 v[236:239], v255, s[12:15], s31 offen offset:320
    s_waitcnt vmcnt(0)
    v_mfma_f32_16x16x32_bf16 v[144:147], v[228:231], v[168:171], v[144:147]
    v_mfma_f32_16x16x32_bf16 v[148:151], v[228:231], v[192:195], v[148:151]
    v_mfma_f32_16x16x32_bf16 v[152:155], v[228:231], v[216:219], v[152:155]
    v_mfma_f32_16x16x32_bf16 v[144:147], v[232:235], v[172:175], v[144:147]
    v_mfma_f32_16x16x32_bf16 v[148:151], v[232:235], v[196:199], v[148:151]
    v_mfma_f32_16x16x32_bf16 v[152:155], v[232:235], v[220:223], v[152:155]
    v_mfma_f32_16x16x32_bf16 v[144:147], v[236:239], v[176:179], v[144:147]
    v_mfma_f32_16x16x32_bf16 v[148:151], v[236:239], v[200:203], v[148:151]
    v_mfma_f32_16x16x32_bf16 v[152:155], v[236:239], v[224:227], v[152:155]
    s_nop 7
    s_nop 7
    s_nop 7
    s_add_u32 s31, s31, 6144
    v_fma_f32 v144, v144, s29, -v245
    v_fma_f32 v145, v145, s29, -v245
    v_fma_f32 v146, v146, s29, -v245
    v_fma_f32 v147, v147, s29, -v245
    v_fma_f32 v148, v148, s29, -v247
    v_fma_f32 v149, v149, s29, -v247
    v_fma_f32 v150, v150, s29, -v247
    v_fma_f32 v151, v151, s29, -v247
    v_fma_f32 v152, v152, s29, -v249
    v_fma_f32 v153, v153, s29, -v249
    v_fma_f32 v154, v154, s29, -v249
    v_fma_f32 v155, v155, s29, -v249
    v_exp_f32 v144, v144
    v_exp_f32 v145, v145
    v_exp_f32 v146, v146
    v_exp_f32 v147, v147
    v_cvt_pk_bf16_f32 v74, v144, v145
    v_exp_f32 v148, v148
    v_exp_f32 v149, v149
    v_cvt_pk_bf16_f32 v75, v146, v147
    v_exp_f32 v150, v150
    v_exp_f32 v151, v151
    v_cvt_pk_bf16_f32 v78, v148, v149
    v_exp_f32 v152, v152
    v_exp_f32 v153, v153
    v_cvt_pk_bf16_f32 v79, v150, v151
    v_exp_f32 v154, v154
    v_exp_f32 v155, v155
    v_cvt_pk_bf16_f32 v82, v152, v153
    v_cvt_pk_bf16_f32 v83, v154, v155
    buffer_load_dwordx4 v[228:231], v255, s[12:15], s31 offen offset:0
    buffer_load_dwordx4 v[232:235], v255, s[12:15], s31 offen offset:64
    buffer_load_dwordx4 v[236:239], v255, s[12:15], s31 offen offset:128
    s_waitcnt vmcnt(0)
    v_mfma_f32_16x16x32_bf16 v[84:87], v[228:231], v[156:159], 0
    v_mfma_f32_16x16x32_bf16 v[88:91], v[228:231], v[180:183], 0
    v_mfma_f32_16x16x32_bf16 v[92:95], v[228:231], v[204:207], 0
    v_mfma_f32_16x16x32_bf16 v[84:87], v[232:235], v[160:163], v[84:87]
    v_mfma_f32_16x16x32_bf16 v[88:91], v[232:235], v[184:187], v[88:91]
    v_mfma_f32_16x16x32_bf16 v[92:95], v[232:235], v[208:211], v[92:95]
    v_mfma_f32_16x16x32_bf16 v[84:87], v[236:239], v[164:167], v[84:87]
    v_mfma_f32_16x16x32_bf16 v[88:91], v[236:239], v[188:191], v[88:91]
    v_mfma_f32_16x16x32_bf16 v[92:95], v[236:239], v[212:215], v[92:95]
    s_nop 7
    s_nop 7
    s_nop 7
    buffer_load_dwordx4 v[228:231], v255, s[12:15], s31 offen offset:192
    buffer_load_dwordx4 v[232:235], v255, s[12:15], s31 offen offset:256
    buffer_load_dwordx4 v[236:239], v255, s[12:15], s31 offen offset:320
    s_waitcnt vmcnt(0)
    v_mfma_f32_16x16x32_bf16 v[84:87], v[228:231], v[168:171], v[84:87]
    v_mfma_f32_16x16x32_bf16 v[88:91], v[228:231], v[192:195], v[88:91]
    v_mfma_f32_16x16x32_bf16 v[92:95], v[228:231], v[216:219], v[92:95]
    v_mfma_f32_16x16x32_bf16 v[84:87], v[232:235], v[172:175], v[84:87]
    v_mfma_f32_16x16x32_bf16 v[88:91], v[232:235], v[196:199], v[88:91]
    v_mfma_f32_16x16x32_bf16 v[92:95], v[232:235], v[220:223], v[92:95]
    v_mfma_f32_16x16x32_bf16 v[84:87], v[236:239], v[176:179], v[84:87]
    v_mfma_f32_16x16x32_bf16 v[88:91], v[236:239], v[200:203], v[88:91]
    v_mfma_f32_16x16x32_bf16 v[92:95], v[236:239], v[224:227], v[92:95]
    s_nop 7
    s_nop 7
    s_nop 7
    s_add_u32 s31, s31, 6144
    v_fma_f32 v84, v84, s29, -v245
    v_fma_f32 v85, v85, s29, -v245
    v_fma_f32 v86, v86, s29, -v245
    v_fma_f32 v87, v87, s29, -v245
    v_fma_f32 v88, v88, s29, -v247
    v_fma_f32 v89, v89, s29, -v247
    v_fma_f32 v90, v90, s29, -v247
    v_fma_f32 v91, v91, s29, -v247
    v_fma_f32 v92, v92, s29, -v249
    v_fma_f32 v93, v93, s29, -v249
    v_fma_f32 v94, v94, s29, -v249
    v_fma_f32 v95, v95, s29, -v249
    v_exp_f32 v84, v84
    v_exp_f32 v85, v85
    v_exp_f32 v86, v86
    v_exp_f32 v87, v87
    v_cvt_pk_bf16_f32 v84, v84, v85
    v_exp_f32 v88, v88
    v_exp_f32 v89, v89
    v_cvt_pk_bf16_f32 v85, v86, v87
    v_exp_f32 v90, v90
    v_exp_f32 v91, v91
    v_cvt_pk_bf16_f32 v88, v88, v89
    v_exp_f32 v92, v92
    v_exp_f32 v93, v93
    v_cvt_pk_bf16_f32 v89, v90, v91
    v_exp_f32 v94, v94
    v_exp_f32 v95, v95
    v_cvt_pk_bf16_f32 v92, v92, v93
    v_cvt_pk_bf16_f32 v93, v94, v95
    buffer_load_dwordx4 v[228:231], v255, s[12:15], s31 offen offset:0
    buffer_load_dwordx4 v[232:235], v255, s[12:15], s31 offen offset:64
    buffer_load_dwordx4 v[236:239], v255, s[12:15], s31 offen offset:128
    s_waitcnt vmcnt(0)
    v_mfma_f32_16x16x32_bf16 v[144:147], v[228:231], v[156:159], 0
    v_mfma_f32_16x16x32_bf16 v[148:151], v[228:231], v[180:183], 0
    v_mfma_f32_16x16x32_bf16 v[152:155], v[228:231], v[204:207], 0
    v_mfma_f32_16x16x32_bf16 v[144:147], v[232:235], v[160:163], v[144:147]
    v_mfma_f32_16x16x32_bf16 v[148:151], v[232:235], v[184:187], v[148:151]
    v_mfma_f32_16x16x32_bf16 v[152:155], v[232:235], v[208:211], v[152:155]
    v_mfma_f32_16x16x32_bf16 v[144:147], v[236:239], v[164:167], v[144:147]
    v_mfma_f32_16x16x32_bf16 v[148:151], v[236:239], v[188:191], v[148:151]
    v_mfma_f32_16x16x32_bf16 v[152:155], v[236:239], v[212:215], v[152:155]
    s_nop 7
    s_nop 7
    s_nop 7
    buffer_load_dwordx4 v[228:231], v255, s[12:15], s31 offen offset:192
    buffer_load_dwordx4 v[232:235], v255, s[12:15], s31 offen offset:256
    buffer_load_dwordx4 v[236:239], v255, s[12:15], s31 offen offset:320
    s_waitcnt vmcnt(0)
    v_mfma_f32_16x16x32_bf16 v[144:147], v[228:231], v[168:171], v[144:147]
    v_mfma_f32_16x16x32_bf16 v[148:151], v[228:231], v[192:195], v[148:151]
    v_mfma_f32_16x16x32_bf16 v[152:155], v[228:231], v[216:219], v[152:155]
    v_mfma_f32_16x16x32_bf16 v[144:147], v[232:235], v[172:175], v[144:147]
    v_mfma_f32_16x16x32_bf16 v[148:151], v[232:235], v[196:199], v[148:151]
    v_mfma_f32_16x16x32_bf16 v[152:155], v[232:235], v[220:223], v[152:155]
    v_mfma_f32_16x16x32_bf16 v[144:147], v[236:239], v[176:179], v[144:147]
    v_mfma_f32_16x16x32_bf16 v[148:151], v[236:239], v[200:203], v[148:151]
    v_mfma_f32_16x16x32_bf16 v[152:155], v[236:239], v[224:227], v[152:155]
    s_nop 7
    s_nop 7
    s_nop 7
    s_add_u32 s31, s31, 6144
    v_fma_f32 v144, v144, s29, -v245
    v_fma_f32 v145, v145, s29, -v245
    v_fma_f32 v146, v146, s29, -v245
    v_fma_f32 v147, v147, s29, -v245
    v_fma_f32 v148, v148, s29, -v247
    v_fma_f32 v149, v149, s29, -v247
    v_fma_f32 v150, v150, s29, -v247
    v_fma_f32 v151, v151, s29, -v247
    v_fma_f32 v152, v152, s29, -v249
    v_fma_f32 v153, v153, s29, -v249
    v_fma_f32 v154, v154, s29, -v249
    v_fma_f32 v155, v155, s29, -v249
    v_exp_f32 v144, v144
    v_exp_f32 v145, v145
    v_exp_f32 v146, v146
    v_exp_f32 v147, v147
    v_cvt_pk_bf16_f32 v86, v144, v145
    v_exp_f32 v148, v148
    v_exp_f32 v149, v149
    v_cvt_pk_bf16_f32 v87, v146, v147
    v_exp_f32 v150, v150
    v_exp_f32 v151, v151
    v_cvt_pk_bf16_f32 v90, v148, v149
    v_exp_f32 v152, v152
    v_exp_f32 v153, v153
    v_cvt_pk_bf16_f32 v91, v150, v151
    v_exp_f32 v154, v154
    v_exp_f32 v155, v155
    v_cvt_pk_bf16_f32 v94, v152, v153
    v_cvt_pk_bf16_f32 v95, v154, v155
    buffer_load_dwordx4 v[228:231], v255, s[12:15], s31 offen offset:0
    buffer_load_dwordx4 v[232:235], v255, s[12:15], s31 offen offset:64
    buffer_load_dwordx4 v[236:239], v255, s[12:15], s31 offen offset:128
    s_waitcnt vmcnt(0)
    v_mfma_f32_16x16x32_bf16 v[96:99], v[228:231], v[156:159], 0
    v_mfma_f32_16x16x32_bf16 v[100:103], v[228:231], v[180:183], 0
    v_mfma_f32_16x16x32_bf16 v[104:107], v[228:231], v[204:207], 0
    v_mfma_f32_16x16x32_bf16 v[96:99], v[232:235], v[160:163], v[96:99]
    v_mfma_f32_16x16x32_bf16 v[100:103], v[232:235], v[184:187], v[100:103]
    v_mfma_f32_16x16x32_bf16 v[104:107], v[232:235], v[208:211], v[104:107]
    v_mfma_f32_16x16x32_bf16 v[96:99], v[236:239], v[164:167], v[96:99]
    v_mfma_f32_16x16x32_bf16 v[100:103], v[236:239], v[188:191], v[100:103]
    v_mfma_f32_16x16x32_bf16 v[104:107], v[236:239], v[212:215], v[104:107]
    s_nop 7
    s_nop 7
    s_nop 7
    buffer_load_dwordx4 v[228:231], v255, s[12:15], s31 offen offset:192
    buffer_load_dwordx4 v[232:235], v255, s[12:15], s31 offen offset:256
    buffer_load_dwordx4 v[236:239], v255, s[12:15], s31 offen offset:320
    s_waitcnt vmcnt(0)
    v_mfma_f32_16x16x32_bf16 v[96:99], v[228:231], v[168:171], v[96:99]
    v_mfma_f32_16x16x32_bf16 v[100:103], v[228:231], v[192:195], v[100:103]
    v_mfma_f32_16x16x32_bf16 v[104:107], v[228:231], v[216:219], v[104:107]
    v_mfma_f32_16x16x32_bf16 v[96:99], v[232:235], v[172:175], v[96:99]
    v_mfma_f32_16x16x32_bf16 v[100:103], v[232:235], v[196:199], v[100:103]
    v_mfma_f32_16x16x32_bf16 v[104:107], v[232:235], v[220:223], v[104:107]
    v_mfma_f32_16x16x32_bf16 v[96:99], v[236:239], v[176:179], v[96:99]
    v_mfma_f32_16x16x32_bf16 v[100:103], v[236:239], v[200:203], v[100:103]
    v_mfma_f32_16x16x32_bf16 v[104:107], v[236:239], v[224:227], v[104:107]
    s_nop 7
    s_nop 7
    s_nop 7
    s_add_u32 s31, s31, 6144
    v_fma_f32 v96, v96, s29, -v245
    v_fma_f32 v97, v97, s29, -v245
    v_fma_f32 v98, v98, s29, -v245
    v_fma_f32 v99, v99, s29, -v245
    v_fma_f32 v100, v100, s29, -v247
    v_fma_f32 v101, v101, s29, -v247
    v_fma_f32 v102, v102, s29, -v247
    v_fma_f32 v103, v103, s29, -v247
    v_fma_f32 v104, v104, s29, -v249
    v_fma_f32 v105, v105, s29, -v249
    v_fma_f32 v106, v106, s29, -v249
    v_fma_f32 v107, v107, s29, -v249
    v_exp_f32 v96, v96
    v_exp_f32 v97, v97
    v_exp_f32 v98, v98
    v_exp_f32 v99, v99
    v_cvt_pk_bf16_f32 v96, v96, v97
    v_exp_f32 v100, v100
    v_exp_f32 v101, v101
    v_cvt_pk_bf16_f32 v97, v98, v99
    v_exp_f32 v102, v102
    v_exp_f32 v103, v103
    v_cvt_pk_bf16_f32 v100, v100, v101
    v_exp_f32 v104, v104
    v_exp_f32 v105, v105
    v_cvt_pk_bf16_f32 v101, v102, v103
    v_exp_f32 v106, v106
    v_exp_f32 v107, v107
    v_cvt_pk_bf16_f32 v104, v104, v105
    v_cvt_pk_bf16_f32 v105, v106, v107
    buffer_load_dwordx4 v[228:231], v255, s[12:15], s31 offen offset:0
    buffer_load_dwordx4 v[232:235], v255, s[12:15], s31 offen offset:64
    buffer_load_dwordx4 v[236:239], v255, s[12:15], s31 offen offset:128
    s_waitcnt vmcnt(0)
    v_mfma_f32_16x16x32_bf16 v[144:147], v[228:231], v[156:159], 0
    v_mfma_f32_16x16x32_bf16 v[148:151], v[228:231], v[180:183], 0
    v_mfma_f32_16x16x32_bf16 v[152:155], v[228:231], v[204:207], 0
    v_mfma_f32_16x16x32_bf16 v[144:147], v[232:235], v[160:163], v[144:147]
    v_mfma_f32_16x16x32_bf16 v[148:151], v[232:235], v[184:187], v[148:151]
    v_mfma_f32_16x16x32_bf16 v[152:155], v[232:235], v[208:211], v[152:155]
    v_mfma_f32_16x16x32_bf16 v[144:147], v[236:239], v[164:167], v[144:147]
    v_mfma_f32_16x16x32_bf16 v[148:151], v[236:239], v[188:191], v[148:151]
    v_mfma_f32_16x16x32_bf16 v[152:155], v[236:239], v[212:215], v[152:155]
    s_nop 7
    s_nop 7
    s_nop 7
    buffer_load_dwordx4 v[228:231], v255, s[12:15], s31 offen offset:192
    buffer_load_dwordx4 v[232:235], v255, s[12:15], s31 offen offset:256
    buffer_load_dwordx4 v[236:239], v255, s[12:15], s31 offen offset:320
    s_waitcnt vmcnt(0)
    v_mfma_f32_16x16x32_bf16 v[144:147], v[228:231], v[168:171], v[144:147]
    v_mfma_f32_16x16x32_bf16 v[148:151], v[228:231], v[192:195], v[148:151]
    v_mfma_f32_16x16x32_bf16 v[152:155], v[228:231], v[216:219], v[152:155]
    v_mfma_f32_16x16x32_bf16 v[144:147], v[232:235], v[172:175], v[144:147]
    v_mfma_f32_16x16x32_bf16 v[148:151], v[232:235], v[196:199], v[148:151]
    v_mfma_f32_16x16x32_bf16 v[152:155], v[232:235], v[220:223], v[152:155]
    v_mfma_f32_16x16x32_bf16 v[144:147], v[236:239], v[176:179], v[144:147]
    v_mfma_f32_16x16x32_bf16 v[148:151], v[236:239], v[200:203], v[148:151]
    v_mfma_f32_16x16x32_bf16 v[152:155], v[236:239], v[224:227], v[152:155]
    s_nop 7
    s_nop 7
    s_nop 7
    s_add_u32 s31, s31, 6144
    v_fma_f32 v144, v144, s29, -v245
    v_fma_f32 v145, v145, s29, -v245
    v_fma_f32 v146, v146, s29, -v245
    v_fma_f32 v147, v147, s29, -v245
    v_fma_f32 v148, v148, s29, -v247
    v_fma_f32 v149, v149, s29, -v247
    v_fma_f32 v150, v150, s29, -v247
    v_fma_f32 v151, v151, s29, -v247
    v_fma_f32 v152, v152, s29, -v249
    v_fma_f32 v153, v153, s29, -v249
    v_fma_f32 v154, v154, s29, -v249
    v_fma_f32 v155, v155, s29, -v249
    v_exp_f32 v144, v144
    v_exp_f32 v145, v145
    v_exp_f32 v146, v146
    v_exp_f32 v147, v147
    v_cvt_pk_bf16_f32 v98, v144, v145
    v_exp_f32 v148, v148
    v_exp_f32 v149, v149
    v_cvt_pk_bf16_f32 v99, v146, v147
    v_exp_f32 v150, v150
    v_exp_f32 v151, v151
    v_cvt_pk_bf16_f32 v102, v148, v149
    v_exp_f32 v152, v152
    v_exp_f32 v153, v153
    v_cvt_pk_bf16_f32 v103, v150, v151
    v_exp_f32 v154, v154
    v_exp_f32 v155, v155
    v_cvt_pk_bf16_f32 v106, v152, v153
    v_cvt_pk_bf16_f32 v107, v154, v155
    buffer_load_dwordx4 v[228:231], v255, s[12:15], s31 offen offset:0
    buffer_load_dwordx4 v[232:235], v255, s[12:15], s31 offen offset:64
    buffer_load_dwordx4 v[236:239], v255, s[12:15], s31 offen offset:128
    s_waitcnt vmcnt(0)
    v_mfma_f32_16x16x32_bf16 v[108:111], v[228:231], v[156:159], 0
    v_mfma_f32_16x16x32_bf16 v[112:115], v[228:231], v[180:183], 0
    v_mfma_f32_16x16x32_bf16 v[116:119], v[228:231], v[204:207], 0
    v_mfma_f32_16x16x32_bf16 v[108:111], v[232:235], v[160:163], v[108:111]
    v_mfma_f32_16x16x32_bf16 v[112:115], v[232:235], v[184:187], v[112:115]
    v_mfma_f32_16x16x32_bf16 v[116:119], v[232:235], v[208:211], v[116:119]
    v_mfma_f32_16x16x32_bf16 v[108:111], v[236:239], v[164:167], v[108:111]
    v_mfma_f32_16x16x32_bf16 v[112:115], v[236:239], v[188:191], v[112:115]
    v_mfma_f32_16x16x32_bf16 v[116:119], v[236:239], v[212:215], v[116:119]
    s_nop 7
    s_nop 7
    s_nop 7
    buffer_load_dwordx4 v[228:231], v255, s[12:15], s31 offen offset:192
    buffer_load_dwordx4 v[232:235], v255, s[12:15], s31 offen offset:256
    buffer_load_dwordx4 v[236:239], v255, s[12:15], s31 offen offset:320
    s_waitcnt vmcnt(0)
    v_mfma_f32_16x16x32_bf16 v[108:111], v[228:231], v[168:171], v[108:111]
    v_mfma_f32_16x16x32_bf16 v[112:115], v[228:231], v[192:195], v[112:115]
    v_mfma_f32_16x16x32_bf16 v[116:119], v[228:231], v[216:219], v[116:119]
    v_mfma_f32_16x16x32_bf16 v[108:111], v[232:235], v[172:175], v[108:111]
    v_mfma_f32_16x16x32_bf16 v[112:115], v[232:235], v[196:199], v[112:115]
    v_mfma_f32_16x16x32_bf16 v[116:119], v[232:235], v[220:223], v[116:119]
    v_mfma_f32_16x16x32_bf16 v[108:111], v[236:239], v[176:179], v[108:111]
    v_mfma_f32_16x16x32_bf16 v[112:115], v[236:239], v[200:203], v[112:115]
    v_mfma_f32_16x16x32_bf16 v[116:119], v[236:239], v[224:227], v[116:119]
    s_nop 7
    s_nop 7
    s_nop 7
    s_add_u32 s31, s31, 6144
    v_fma_f32 v108, v108, s29, -v245
    v_fma_f32 v109, v109, s29, -v245
    v_fma_f32 v110, v110, s29, -v245
    v_fma_f32 v111, v111, s29, -v245
    v_fma_f32 v112, v112, s29, -v247
    v_fma_f32 v113, v113, s29, -v247
    v_fma_f32 v114, v114, s29, -v247
    v_fma_f32 v115, v115, s29, -v247
    v_fma_f32 v116, v116, s29, -v249
    v_fma_f32 v117, v117, s29, -v249
    v_fma_f32 v118, v118, s29, -v249
    v_fma_f32 v119, v119, s29, -v249
    v_exp_f32 v108, v108
    v_exp_f32 v109, v109
    v_exp_f32 v110, v110
    v_exp_f32 v111, v111
    v_cvt_pk_bf16_f32 v108, v108, v109
    v_exp_f32 v112, v112
    v_exp_f32 v113, v113
    v_cvt_pk_bf16_f32 v109, v110, v111
    v_exp_f32 v114, v114
    v_exp_f32 v115, v115
    v_cvt_pk_bf16_f32 v112, v112, v113
    v_exp_f32 v116, v116
    v_exp_f32 v117, v117
    v_cvt_pk_bf16_f32 v113, v114, v115
    v_exp_f32 v118, v118
    v_exp_f32 v119, v119
    v_cvt_pk_bf16_f32 v116, v116, v117
    v_cvt_pk_bf16_f32 v117, v118, v119
    buffer_load_dwordx4 v[228:231], v255, s[12:15], s31 offen offset:0
    buffer_load_dwordx4 v[232:235], v255, s[12:15], s31 offen offset:64
    buffer_load_dwordx4 v[236:239], v255, s[12:15], s31 offen offset:128
    s_waitcnt vmcnt(0)
    v_mfma_f32_16x16x32_bf16 v[144:147], v[228:231], v[156:159], 0
    v_mfma_f32_16x16x32_bf16 v[148:151], v[228:231], v[180:183], 0
    v_mfma_f32_16x16x32_bf16 v[152:155], v[228:231], v[204:207], 0
    v_mfma_f32_16x16x32_bf16 v[144:147], v[232:235], v[160:163], v[144:147]
    v_mfma_f32_16x16x32_bf16 v[148:151], v[232:235], v[184:187], v[148:151]
    v_mfma_f32_16x16x32_bf16 v[152:155], v[232:235], v[208:211], v[152:155]
    v_mfma_f32_16x16x32_bf16 v[144:147], v[236:239], v[164:167], v[144:147]
    v_mfma_f32_16x16x32_bf16 v[148:151], v[236:239], v[188:191], v[148:151]
    v_mfma_f32_16x16x32_bf16 v[152:155], v[236:239], v[212:215], v[152:155]
    s_nop 7
    s_nop 7
    s_nop 7
    buffer_load_dwordx4 v[228:231], v255, s[12:15], s31 offen offset:192
    buffer_load_dwordx4 v[232:235], v255, s[12:15], s31 offen offset:256
    buffer_load_dwordx4 v[236:239], v255, s[12:15], s31 offen offset:320
    s_waitcnt vmcnt(0)
    v_mfma_f32_16x16x32_bf16 v[144:147], v[228:231], v[168:171], v[144:147]
    v_mfma_f32_16x16x32_bf16 v[148:151], v[228:231], v[192:195], v[148:151]
    v_mfma_f32_16x16x32_bf16 v[152:155], v[228:231], v[216:219], v[152:155]
    v_mfma_f32_16x16x32_bf16 v[144:147], v[232:235], v[172:175], v[144:147]
    v_mfma_f32_16x16x32_bf16 v[148:151], v[232:235], v[196:199], v[148:151]
    v_mfma_f32_16x16x32_bf16 v[152:155], v[232:235], v[220:223], v[152:155]
    v_mfma_f32_16x16x32_bf16 v[144:147], v[236:239], v[176:179], v[144:147]
    v_mfma_f32_16x16x32_bf16 v[148:151], v[236:239], v[200:203], v[148:151]
    v_mfma_f32_16x16x32_bf16 v[152:155], v[236:239], v[224:227], v[152:155]
    s_nop 7
    s_nop 7
    s_nop 7
    s_add_u32 s31, s31, 6144
    v_fma_f32 v144, v144, s29, -v245
    v_fma_f32 v145, v145, s29, -v245
    v_fma_f32 v146, v146, s29, -v245
    v_fma_f32 v147, v147, s29, -v245
    v_fma_f32 v148, v148, s29, -v247
    v_fma_f32 v149, v149, s29, -v247
    v_fma_f32 v150, v150, s29, -v247
    v_fma_f32 v151, v151, s29, -v247
    v_fma_f32 v152, v152, s29, -v249
    v_fma_f32 v153, v153, s29, -v249
    v_fma_f32 v154, v154, s29, -v249
    v_fma_f32 v155, v155, s29, -v249
    v_exp_f32 v144, v144
    v_exp_f32 v145, v145
    v_exp_f32 v146, v146
    v_exp_f32 v147, v147
    v_cvt_pk_bf16_f32 v110, v144, v145
    v_exp_f32 v148, v148
    v_exp_f32 v149, v149
    v_cvt_pk_bf16_f32 v111, v146, v147
    v_exp_f32 v150, v150
    v_exp_f32 v151, v151
    v_cvt_pk_bf16_f32 v114, v148, v149
    v_exp_f32 v152, v152
    v_exp_f32 v153, v153
    v_cvt_pk_bf16_f32 v115, v150, v151
    v_exp_f32 v154, v154
    v_exp_f32 v155, v155
    v_cvt_pk_bf16_f32 v118, v152, v153
    v_cvt_pk_bf16_f32 v119, v154, v155
    buffer_load_dwordx4 v[228:231], v255, s[12:15], s31 offen offset:0
    buffer_load_dwordx4 v[232:235], v255, s[12:15], s31 offen offset:64
    buffer_load_dwordx4 v[236:239], v255, s[12:15], s31 offen offset:128
    s_waitcnt vmcnt(0)
    v_mfma_f32_16x16x32_bf16 v[120:123], v[228:231], v[156:159], 0
    v_mfma_f32_16x16x32_bf16 v[124:127], v[228:231], v[180:183], 0
    v_mfma_f32_16x16x32_bf16 v[128:131], v[228:231], v[204:207], 0
    v_mfma_f32_16x16x32_bf16 v[120:123], v[232:235], v[160:163], v[120:123]
    v_mfma_f32_16x16x32_bf16 v[124:127], v[232:235], v[184:187], v[124:127]
    v_mfma_f32_16x16x32_bf16 v[128:131], v[232:235], v[208:211], v[128:131]
    v_mfma_f32_16x16x32_bf16 v[120:123], v[236:239], v[164:167], v[120:123]
    v_mfma_f32_16x16x32_bf16 v[124:127], v[236:239], v[188:191], v[124:127]
    v_mfma_f32_16x16x32_bf16 v[128:131], v[236:239], v[212:215], v[128:131]
    s_nop 7
    s_nop 7
    s_nop 7
    buffer_load_dwordx4 v[228:231], v255, s[12:15], s31 offen offset:192
    buffer_load_dwordx4 v[232:235], v255, s[12:15], s31 offen offset:256
    buffer_load_dwordx4 v[236:239], v255, s[12:15], s31 offen offset:320
    s_waitcnt vmcnt(0)
    v_mfma_f32_16x16x32_bf16 v[120:123], v[228:231], v[168:171], v[120:123]
    v_mfma_f32_16x16x32_bf16 v[124:127], v[228:231], v[192:195], v[124:127]
    v_mfma_f32_16x16x32_bf16 v[128:131], v[228:231], v[216:219], v[128:131]
    v_mfma_f32_16x16x32_bf16 v[120:123], v[232:235], v[172:175], v[120:123]
    v_mfma_f32_16x16x32_bf16 v[124:127], v[232:235], v[196:199], v[124:127]
    v_mfma_f32_16x16x32_bf16 v[128:131], v[232:235], v[220:223], v[128:131]
    v_mfma_f32_16x16x32_bf16 v[120:123], v[236:239], v[176:179], v[120:123]
    v_mfma_f32_16x16x32_bf16 v[124:127], v[236:239], v[200:203], v[124:127]
    v_mfma_f32_16x16x32_bf16 v[128:131], v[236:239], v[224:227], v[128:131]
    s_nop 7
    s_nop 7
    s_nop 7
    s_add_u32 s31, s31, 6144
    v_fma_f32 v120, v120, s29, -v245
    v_fma_f32 v121, v121, s29, -v245
    v_fma_f32 v122, v122, s29, -v245
    v_fma_f32 v123, v123, s29, -v245
    v_fma_f32 v124, v124, s29, -v247
    v_fma_f32 v125, v125, s29, -v247
    v_fma_f32 v126, v126, s29, -v247
    v_fma_f32 v127, v127, s29, -v247
    v_fma_f32 v128, v128, s29, -v249
    v_fma_f32 v129, v129, s29, -v249
    v_fma_f32 v130, v130, s29, -v249
    v_fma_f32 v131, v131, s29, -v249
    v_exp_f32 v120, v120
    v_exp_f32 v121, v121
    v_exp_f32 v122, v122
    v_exp_f32 v123, v123
    v_cvt_pk_bf16_f32 v120, v120, v121
    v_exp_f32 v124, v124
    v_exp_f32 v125, v125
    v_cvt_pk_bf16_f32 v121, v122, v123
    v_exp_f32 v126, v126
    v_exp_f32 v127, v127
    v_cvt_pk_bf16_f32 v124, v124, v125
    v_exp_f32 v128, v128
    v_exp_f32 v129, v129
    v_cvt_pk_bf16_f32 v125, v126, v127
    v_exp_f32 v130, v130
    v_exp_f32 v131, v131
    v_cvt_pk_bf16_f32 v128, v128, v129
    v_cvt_pk_bf16_f32 v129, v130, v131
    buffer_load_dwordx4 v[228:231], v255, s[12:15], s31 offen offset:0
    buffer_load_dwordx4 v[232:235], v255, s[12:15], s31 offen offset:64
    buffer_load_dwordx4 v[236:239], v255, s[12:15], s31 offen offset:128
    s_waitcnt vmcnt(0)
    v_mfma_f32_16x16x32_bf16 v[144:147], v[228:231], v[156:159], 0
    v_mfma_f32_16x16x32_bf16 v[148:151], v[228:231], v[180:183], 0
    v_mfma_f32_16x16x32_bf16 v[152:155], v[228:231], v[204:207], 0
    v_mfma_f32_16x16x32_bf16 v[144:147], v[232:235], v[160:163], v[144:147]
    v_mfma_f32_16x16x32_bf16 v[148:151], v[232:235], v[184:187], v[148:151]
    v_mfma_f32_16x16x32_bf16 v[152:155], v[232:235], v[208:211], v[152:155]
    v_mfma_f32_16x16x32_bf16 v[144:147], v[236:239], v[164:167], v[144:147]
    v_mfma_f32_16x16x32_bf16 v[148:151], v[236:239], v[188:191], v[148:151]
    v_mfma_f32_16x16x32_bf16 v[152:155], v[236:239], v[212:215], v[152:155]
    s_nop 7
    s_nop 7
    s_nop 7
    buffer_load_dwordx4 v[228:231], v255, s[12:15], s31 offen offset:192
    buffer_load_dwordx4 v[232:235], v255, s[12:15], s31 offen offset:256
    buffer_load_dwordx4 v[236:239], v255, s[12:15], s31 offen offset:320
    s_waitcnt vmcnt(0)
    v_mfma_f32_16x16x32_bf16 v[144:147], v[228:231], v[168:171], v[144:147]
    v_mfma_f32_16x16x32_bf16 v[148:151], v[228:231], v[192:195], v[148:151]
    v_mfma_f32_16x16x32_bf16 v[152:155], v[228:231], v[216:219], v[152:155]
    v_mfma_f32_16x16x32_bf16 v[144:147], v[232:235], v[172:175], v[144:147]
    v_mfma_f32_16x16x32_bf16 v[148:151], v[232:235], v[196:199], v[148:151]
    v_mfma_f32_16x16x32_bf16 v[152:155], v[232:235], v[220:223], v[152:155]
    v_mfma_f32_16x16x32_bf16 v[144:147], v[236:239], v[176:179], v[144:147]
    v_mfma_f32_16x16x32_bf16 v[148:151], v[236:239], v[200:203], v[148:151]
    v_mfma_f32_16x16x32_bf16 v[152:155], v[236:239], v[224:227], v[152:155]
    s_nop 7
    s_nop 7
    s_nop 7
    s_add_u32 s31, s31, 6144
    v_fma_f32 v144, v144, s29, -v245
    v_fma_f32 v145, v145, s29, -v245
    v_fma_f32 v146, v146, s29, -v245
    v_fma_f32 v147, v147, s29, -v245
    v_fma_f32 v148, v148, s29, -v247
    v_fma_f32 v149, v149, s29, -v247
    v_fma_f32 v150, v150, s29, -v247
    v_fma_f32 v151, v151, s29, -v247
    v_fma_f32 v152, v152, s29, -v249
    v_fma_f32 v153, v153, s29, -v249
    v_fma_f32 v154, v154, s29, -v249
    v_fma_f32 v155, v155, s29, -v249
    v_exp_f32 v144, v144
    v_exp_f32 v145, v145
    v_exp_f32 v146, v146
    v_exp_f32 v147, v147
    v_cvt_pk_bf16_f32 v122, v144, v145
    v_exp_f32 v148, v148
    v_exp_f32 v149, v149
    v_cvt_pk_bf16_f32 v123, v146, v147
    v_exp_f32 v150, v150
    v_exp_f32 v151, v151
    v_cvt_pk_bf16_f32 v126, v148, v149
    v_exp_f32 v152, v152
    v_exp_f32 v153, v153
    v_cvt_pk_bf16_f32 v127, v150, v151
    v_exp_f32 v154, v154
    v_exp_f32 v155, v155
    v_cvt_pk_bf16_f32 v130, v152, v153
    v_cvt_pk_bf16_f32 v131, v154, v155
    buffer_load_dwordx4 v[228:231], v255, s[12:15], s31 offen offset:0
    buffer_load_dwordx4 v[232:235], v255, s[12:15], s31 offen offset:64
    buffer_load_dwordx4 v[236:239], v255, s[12:15], s31 offen offset:128
    s_waitcnt vmcnt(0)
    v_mfma_f32_16x16x32_bf16 v[132:135], v[228:231], v[156:159], 0
    v_mfma_f32_16x16x32_bf16 v[136:139], v[228:231], v[180:183], 0
    v_mfma_f32_16x16x32_bf16 v[140:143], v[228:231], v[204:207], 0
    v_mfma_f32_16x16x32_bf16 v[132:135], v[232:235], v[160:163], v[132:135]
    v_mfma_f32_16x16x32_bf16 v[136:139], v[232:235], v[184:187], v[136:139]
    v_mfma_f32_16x16x32_bf16 v[140:143], v[232:235], v[208:211], v[140:143]
    v_mfma_f32_16x16x32_bf16 v[132:135], v[236:239], v[164:167], v[132:135]
    v_mfma_f32_16x16x32_bf16 v[136:139], v[236:239], v[188:191], v[136:139]
    v_mfma_f32_16x16x32_bf16 v[140:143], v[236:239], v[212:215], v[140:143]
    s_nop 7
    s_nop 7
    s_nop 7
    buffer_load_dwordx4 v[228:231], v255, s[12:15], s31 offen offset:192
    buffer_load_dwordx4 v[232:235], v255, s[12:15], s31 offen offset:256
    buffer_load_dwordx4 v[236:239], v255, s[12:15], s31 offen offset:320
    s_waitcnt vmcnt(0)
    v_mfma_f32_16x16x32_bf16 v[132:135], v[228:231], v[168:171], v[132:135]
    v_mfma_f32_16x16x32_bf16 v[136:139], v[228:231], v[192:195], v[136:139]
    v_mfma_f32_16x16x32_bf16 v[140:143], v[228:231], v[216:219], v[140:143]
    v_mfma_f32_16x16x32_bf16 v[132:135], v[232:235], v[172:175], v[132:135]
    v_mfma_f32_16x16x32_bf16 v[136:139], v[232:235], v[196:199], v[136:139]
    v_mfma_f32_16x16x32_bf16 v[140:143], v[232:235], v[220:223], v[140:143]
    v_mfma_f32_16x16x32_bf16 v[132:135], v[236:239], v[176:179], v[132:135]
    v_mfma_f32_16x16x32_bf16 v[136:139], v[236:239], v[200:203], v[136:139]
    v_mfma_f32_16x16x32_bf16 v[140:143], v[236:239], v[224:227], v[140:143]
    s_nop 7
    s_nop 7
    s_nop 7
    s_add_u32 s31, s31, 6144
    v_fma_f32 v132, v132, s29, -v245
    v_fma_f32 v133, v133, s29, -v245
    v_fma_f32 v134, v134, s29, -v245
    v_fma_f32 v135, v135, s29, -v245
    v_fma_f32 v136, v136, s29, -v247
    v_fma_f32 v137, v137, s29, -v247
    v_fma_f32 v138, v138, s29, -v247
    v_fma_f32 v139, v139, s29, -v247
    v_fma_f32 v140, v140, s29, -v249
    v_fma_f32 v141, v141, s29, -v249
    v_fma_f32 v142, v142, s29, -v249
    v_fma_f32 v143, v143, s29, -v249
    v_exp_f32 v132, v132
    v_exp_f32 v133, v133
    v_exp_f32 v134, v134
    v_exp_f32 v135, v135
    v_cvt_pk_bf16_f32 v132, v132, v133
    v_exp_f32 v136, v136
    v_exp_f32 v137, v137
    v_cvt_pk_bf16_f32 v133, v134, v135
    v_exp_f32 v138, v138
    v_exp_f32 v139, v139
    v_cvt_pk_bf16_f32 v136, v136, v137
    v_exp_f32 v140, v140
    v_exp_f32 v141, v141
    v_cvt_pk_bf16_f32 v137, v138, v139
    v_exp_f32 v142, v142
    v_exp_f32 v143, v143
    v_cvt_pk_bf16_f32 v140, v140, v141
    v_cvt_pk_bf16_f32 v141, v142, v143
    buffer_load_dwordx4 v[228:231], v255, s[12:15], s31 offen offset:0
    buffer_load_dwordx4 v[232:235], v255, s[12:15], s31 offen offset:64
    buffer_load_dwordx4 v[236:239], v255, s[12:15], s31 offen offset:128
    s_waitcnt vmcnt(0)
    v_mfma_f32_16x16x32_bf16 v[144:147], v[228:231], v[156:159], 0
    v_mfma_f32_16x16x32_bf16 v[148:151], v[228:231], v[180:183], 0
    v_mfma_f32_16x16x32_bf16 v[152:155], v[228:231], v[204:207], 0
    v_mfma_f32_16x16x32_bf16 v[144:147], v[232:235], v[160:163], v[144:147]
    v_mfma_f32_16x16x32_bf16 v[148:151], v[232:235], v[184:187], v[148:151]
    v_mfma_f32_16x16x32_bf16 v[152:155], v[232:235], v[208:211], v[152:155]
    v_mfma_f32_16x16x32_bf16 v[144:147], v[236:239], v[164:167], v[144:147]
    v_mfma_f32_16x16x32_bf16 v[148:151], v[236:239], v[188:191], v[148:151]
    v_mfma_f32_16x16x32_bf16 v[152:155], v[236:239], v[212:215], v[152:155]
    s_nop 7
    s_nop 7
    s_nop 7
    buffer_load_dwordx4 v[228:231], v255, s[12:15], s31 offen offset:192
    buffer_load_dwordx4 v[232:235], v255, s[12:15], s31 offen offset:256
    buffer_load_dwordx4 v[236:239], v255, s[12:15], s31 offen offset:320
    s_waitcnt vmcnt(0)
    v_mfma_f32_16x16x32_bf16 v[144:147], v[228:231], v[168:171], v[144:147]
    v_mfma_f32_16x16x32_bf16 v[148:151], v[228:231], v[192:195], v[148:151]
    v_mfma_f32_16x16x32_bf16 v[152:155], v[228:231], v[216:219], v[152:155]
    v_mfma_f32_16x16x32_bf16 v[144:147], v[232:235], v[172:175], v[144:147]
    v_mfma_f32_16x16x32_bf16 v[148:151], v[232:235], v[196:199], v[148:151]
    v_mfma_f32_16x16x32_bf16 v[152:155], v[232:235], v[220:223], v[152:155]
    v_mfma_f32_16x16x32_bf16 v[144:147], v[236:239], v[176:179], v[144:147]
    v_mfma_f32_16x16x32_bf16 v[148:151], v[236:239], v[200:203], v[148:151]
    v_mfma_f32_16x16x32_bf16 v[152:155], v[236:239], v[224:227], v[152:155]
    s_nop 7
    s_nop 7
    s_nop 7
    s_add_u32 s31, s31, 6144
    s_branch L_p2
.section .rodata,"a"
.p2align 6
.amdhsa_kernel standalone__mha_softmax__near_ridge_kernel
  .amdhsa_next_free_vgpr 256
  .amdhsa_next_free_sgpr 100
  .amdhsa_accum_offset 256
  .amdhsa_group_segment_fixed_size 0
  .amdhsa_kernarg_size 48
  .amdhsa_user_sgpr_count 2
  .amdhsa_user_sgpr_kernarg_segment_ptr 1
  .amdhsa_system_sgpr_workgroup_id_x 1
.end_amdhsa_kernel
```
